```python
import torch

def _softmax(x, axis=-1):
    return torch.softmax(x, dim=axis)
def _gelu(x):
    return torch.nn.functional.gelu(x, approximate="tanh")
def _silu(x):
    return torch.nn.functional.silu(x)
def _sigmoid(x):
    return torch.sigmoid(x)
def _layernorm(x, axis=-1, eps=1e-5):
    m = x.mean(dim=axis, keepdim=True)
    v = x.var(dim=axis, keepdim=True, unbiased=False)
    return (x - m) / torch.sqrt(v + eps)
def _scatter_add(tgt, idx, src, axis=0):
    return tgt.clone().index_add_(axis, idx, src)
def _segment_sum(src, seg, n):
    out = torch.zeros((n,) + src.shape[1:], dtype=src.dtype)
    return out.index_add_(0, seg, src)
def _pad(x, pw):
    flat = tuple(v for pair in reversed(pw) for v in pair)
    return torch.nn.functional.pad(x, flat)

kernel_name = 'standalone__mha_softmax__near_ridge'

def setup_inputs():

    _w = (lambda a: (lambda t: t.to(torch.bfloat16) if t.is_floating_point() else t)(torch.as_tensor(a)))
    B, H, Sq, Sk, D = 8, 32, 384, 384, 128
    return {
        "q": _w((lambda *s: torch.randn(*s, dtype=torch.bfloat16) * 0.8)(B, H, Sq, D)),
        "k": _w((lambda *s: torch.randn(*s, dtype=torch.bfloat16) * 0.8)(B, H, Sk, D)),
        "v": _w((lambda *s: torch.randn(*s, dtype=torch.bfloat16) * 0.05)(B, H, Sk, D)),
    }

def reference(q, k, v):
    scale = q.shape[-1] ** -0.5
    scores = torch.einsum("bhqd,bhkd->bhqk", q, k) * scale
    p = _softmax(scores, axis=-1)
    return torch.einsum("bhqk,bhkd->bhqd", p, v)
```

```asm
; @launch grid=(256,1,1) block=(256,1,1) lds=163840
.amdgcn_target "amdgcn-amd-amdhsa--gfx950"
.text
.p2align 12
.globl standalone__mha_softmax__near_ridge_kernel
.p2align 8
.type standalone__mha_softmax__near_ridge_kernel,@function
standalone__mha_softmax__near_ridge_kernel:
  s_cmp_ge_u32 s2, 256
  s_cbranch_scc1 L_end
  s_load_dwordx8 s[4:11], s[0:1], 0
  s_getpc_b64 s[42:43]
L_pc:
  v_lshrrev_b32 v248, 6, v0
  v_and_b32 v255, 63, v0
  s_lshr_b32 s98, s2, 3
  s_lshl_b32 s98, s98, 10
  v_lshl_add_u32 v254, v248, 1, v255
  v_lshl_add_u32 v254, v254, 7, s98
  v_min_u32 v254, L_codeend-L_pc-4, v254
  s_mov_b64 exec, 3
  global_load_dword v247, v254, s[42:43]
  s_mov_b64 exec, -1
  v_readfirstlane_b32 s3, v248
  v_bfe_u32 v249, v255, 2, 2
  v_lshlrev_b32 v0, 8, v249
  v_lshrrev_b32 v250, 4, v255
  v_lshl_add_u32 v0, v250, 6, v0
  v_and_b32 v248, 3, v255
  v_lshl_add_u32 v0, v248, 4, v0
  s_lshl_b32 s32, s3, 12
  s_lshl_b32 s33, s3, 11
  s_mul_i32 s15, s2, 98304
  s_mov_b32 s34, s32
  s_and_b32 s14, s3, 1
  s_lshl_b32 s14, s14, 5
  v_xor_b32 v2, s14, v0
  v_xor_b32 v1, 32, v0
  s_mov_b32 s18, 98304
  s_mov_b32 s19, 0x00020000
  s_mov_b32 s22, 98304
  s_mov_b32 s23, 0x00020000
  s_mov_b32 s30, 98304
  s_mov_b32 s31, 0x00020000
  s_mov_b32 s26, 100352
  s_mov_b32 s27, 0x00020000
  s_waitcnt lgkmcnt(0)
  s_add_u32 s16, s4, s15
  s_addc_u32 s17, s5, 0
  s_add_u32 m0, s32, 65536
  s_xor_b32 s35, s34, 0
  buffer_load_dwordx4 v0, s[16:19], s35 offen nt lds
  buffer_load_dwordx4 v0, s[16:19], s35 offen offset:1024 nt lds
  buffer_load_dwordx4 v0, s[16:19], s35 offen offset:2048 nt lds
  buffer_load_dwordx4 v0, s[16:19], s35 offen offset:3072 nt lds
  s_add_u32 s20, s6, s15
  s_addc_u32 s21, s7, 0
  s_add_u32 s24, s8, s15
  s_addc_u32 s25, s9, 0
  s_add_u32 s28, s10, s15
  s_addc_u32 s29, s11, 0
  s_sub_u32 s24, s24, 2048
  s_subb_u32 s25, s25, 0
  s_add_u32 m0, s32, 0
  s_xor_b32 s35, s33, 0
  buffer_load_dwordx4 v2, s[20:23], s35 offen nt lds
  buffer_load_dwordx4 v2, s[20:23], s35 offen offset:1024 nt lds
  s_add_u32 m0, s32, 81920
  s_xor_b32 s35, s34, 16384
  buffer_load_dwordx4 v0, s[16:19], s35 offen nt lds
  buffer_load_dwordx4 v0, s[16:19], s35 offen offset:1024 nt lds
  buffer_load_dwordx4 v0, s[16:19], s35 offen offset:2048 nt lds
  buffer_load_dwordx4 v0, s[16:19], s35 offen offset:3072 nt lds
  s_getreg_b32 s96, hwreg(HW_REG_XCC_ID, 0, 3)
  s_lshl_b32 s96, s96, 1
  s_lshr_b32 s96, 0x4444, s96
  s_and_b32 s96, s96, 3
  s_cmp_eq_u32 s96, 1
  s_cbranch_scc1 L_alt1
  s_lshr_b32 s98, s2, 3
  s_lshl_b32 s98, s98, 2
  s_add_u32 s98, s98, s3
  s_lshl_b32 s98, s98, 8
  s_mov_b32 s36, 0x3e0293ee
  s_mov_b32 s37, 0x53800000
  s_mov_b32 s38, 0xffff0000
  v_and_b32 v251, 15, v255
  v_lshrrev_b32 v252, 3, v251
  v_lshlrev_b32 v4, 12, v252
  v_lshlrev_b32 v252, 1, v252
  v_xor_b32 v252, v252, v250
  v_lshl_add_u32 v4, v252, 4, v4
  v_bfe_u32 v252, v255, 2, 1
  v_lshl_add_u32 v4, v252, 10, v4
  v_lshl_add_u32 v4, v248, 6, v4
  v_lshlrev_b32 v3, 10, v249
  v_lshl_add_u32 v3, v248, 6, v3
  v_lshl_add_u32 v3, v250, 4, v3
  v_add_u32 v3, s32, v3
  v_lshrrev_b32 v252, 5, v255
  v_lshlrev_b32 v5, 12, v252
  v_bfe_u32 v252, v255, 4, 1
  v_mul_u32_u24 v252, 1056, v252
  v_add_u32 v5, v5, v252
  v_lshl_add_u32 v5, v249, 6, v5
  v_lshl_add_u32 v5, v248, 3, v5
  v_xor_b32 v6, 32, v5
  s_mul_i32 s41, s3, 8704
  s_add_u32 s41, s41, 32768
  v_mul_u32_u24 v252, 272, v251
  v_lshl_add_u32 v252, v250, 3, v252
  v_add_u32 v252, s41, v252
  v_accvgpr_write_b32 a210, v252
  v_add_u32 v252, 4352, v252
  v_accvgpr_write_b32 a211, v252
  v_mul_u32_u24 v252, 272, v250
  v_lshl_add_u32 v252, v251, 4, v252
  v_add_u32 v252, s41, v252
  v_accvgpr_write_b32 a208, v252
  v_lshlrev_b32 v252, 4, v255
  v_accvgpr_write_b32 a209, v252
  v_lshlrev_b32 v252, 8, v251
  v_bfe_u32 v246, v255, 4, 1
  v_lshl_add_u32 v252, v246, 5, v252
  v_lshrrev_b32 v246, 5, v255
  v_lshl_add_u32 v252, v246, 4, v252
  v_accvgpr_write_b32 a220, v252
  v_lshrrev_b32 v252, 5, v255
  v_bfe_u32 v253, v255, 1, 1
  v_cmp_eq_u32 vcc, v252, v253
  v_mov_b32 v252, 0x3f803f80
  v_and_b32 v253, 1, v255
  v_cndmask_b32 v252, 0, v252, vcc
  v_mul_u32_u24 v253, 0xaaaa, v253
  v_add_u32 v7, 0x4444, v253
  v_lshl_or_b32 v7, v7, 16, v7
  v_accvgpr_write_b32 a192, 0
  v_accvgpr_write_b32 a193, 0
  v_accvgpr_write_b32 a194, 0
  v_accvgpr_write_b32 a195, 0
  v_accvgpr_write_b32 a196, 0
  v_accvgpr_write_b32 a197, 0
  v_accvgpr_write_b32 a198, 0
  v_accvgpr_write_b32 a199, 0
  v_accvgpr_write_b32 a200, 0
  v_accvgpr_write_b32 a201, 0
  v_accvgpr_write_b32 a202, 0
  v_accvgpr_write_b32 a203, 0
  v_bfe_u32 v253, v255, 1, 1
  v_mul_u32_u24 v253, 0x3f80, v253
  v_lshl_or_b32 v253, v253, 16, v253
  v_xor_b32 v246, 0x3f803f80, v253
  v_accvgpr_write_b32 a212, v246
  v_accvgpr_write_b32 a216, v253
  v_accvgpr_write_b32 a213, v246
  v_accvgpr_write_b32 a217, v253
  v_accvgpr_write_b32 a214, v246
  v_accvgpr_write_b32 a218, v253
  v_accvgpr_write_b32 a215, v246
  v_accvgpr_write_b32 a219, v253
  v_accvgpr_write_b32 a204, v252
  v_accvgpr_write_b32 a205, v252
  v_accvgpr_write_b32 a206, v252
  v_accvgpr_write_b32 a207, v252
  s_waitcnt vmcnt(9)
  s_add_u32 m0, s32, 0
  s_xor_b32 s35, s33, 0
  buffer_load_dwordx4 v0, s[24:27], s35 offen offset:2048 nt lds
  s_waitcnt vmcnt(9)
  buffer_load_dwordx4 v1, s[24:27], s35 offen offset:3072 nt lds
  s_waitcnt vmcnt(9)
  s_add_u32 m0, s32, 98304
  s_xor_b32 s35, s34, 32768
  buffer_load_dwordx4 v0, s[16:19], s35 offen nt lds
  s_waitcnt vmcnt(9)
  v_add_u32 v3, 0x10000, v3
  ds_read_b128 v[224:227], v3 offset:0
  ds_read_b128 v[228:231], v3 offset:256
  ds_read_b128 v[232:235], v3 offset:512
  ds_read_b128 v[236:239], v3 offset:768
  s_waitcnt lgkmcnt(0)
  v_lshlrev_b32 v240, 16, v224
  v_and_b32 v241, s38, v224
  v_lshlrev_b32 v242, 16, v225
  v_and_b32 v243, s38, v225
  v_lshlrev_b32 v244, 16, v226
  v_and_b32 v245, s38, v226
  v_lshlrev_b32 v246, 16, v227
  v_and_b32 v247, s38, v227
  v_pk_mul_f32 v[240:241], v[240:241], s[36:37] op_sel_hi:[1,0]
  v_pk_mul_f32 v[242:243], v[242:243], s[36:37] op_sel_hi:[1,0]
  v_pk_mul_f32 v[244:245], v[244:245], s[36:37] op_sel_hi:[1,0]
  v_pk_mul_f32 v[246:247], v[246:247], s[36:37] op_sel_hi:[1,0]
  v_cvt_pk_bf16_f32 v240, v240, v241
  v_cvt_pk_bf16_f32 v242, v242, v243
  v_cvt_pk_bf16_f32 v244, v244, v245
  v_cvt_pk_bf16_f32 v246, v246, v247
  v_accvgpr_write_b32 a0, v240
  v_accvgpr_write_b32 a1, v242
  v_accvgpr_write_b32 a2, v244
  v_accvgpr_write_b32 a3, v246
  v_lshlrev_b32 v240, 16, v228
  v_and_b32 v241, s38, v228
  v_lshlrev_b32 v242, 16, v229
  v_and_b32 v243, s38, v229
  v_lshlrev_b32 v244, 16, v230
  v_and_b32 v245, s38, v230
  v_lshlrev_b32 v246, 16, v231
  v_and_b32 v247, s38, v231
  v_pk_mul_f32 v[240:241], v[240:241], s[36:37] op_sel_hi:[1,0]
  v_pk_mul_f32 v[242:243], v[242:243], s[36:37] op_sel_hi:[1,0]
  v_pk_mul_f32 v[244:245], v[244:245], s[36:37] op_sel_hi:[1,0]
  v_pk_mul_f32 v[246:247], v[246:247], s[36:37] op_sel_hi:[1,0]
  v_cvt_pk_bf16_f32 v240, v240, v241
  v_cvt_pk_bf16_f32 v242, v242, v243
  v_cvt_pk_bf16_f32 v244, v244, v245
  v_cvt_pk_bf16_f32 v246, v246, v247
  v_accvgpr_write_b32 a4, v240
  v_accvgpr_write_b32 a5, v242
  v_accvgpr_write_b32 a6, v244
  v_accvgpr_write_b32 a7, v246
  v_lshlrev_b32 v240, 16, v232
  v_and_b32 v241, s38, v232
  v_lshlrev_b32 v242, 16, v233
  v_and_b32 v243, s38, v233
  v_lshlrev_b32 v244, 16, v234
  v_and_b32 v245, s38, v234
  v_lshlrev_b32 v246, 16, v235
  v_and_b32 v247, s38, v235
  v_pk_mul_f32 v[240:241], v[240:241], s[36:37] op_sel_hi:[1,0]
  v_pk_mul_f32 v[242:243], v[242:243], s[36:37] op_sel_hi:[1,0]
  v_pk_mul_f32 v[244:245], v[244:245], s[36:37] op_sel_hi:[1,0]
  v_pk_mul_f32 v[246:247], v[246:247], s[36:37] op_sel_hi:[1,0]
  v_cvt_pk_bf16_f32 v240, v240, v241
  v_cvt_pk_bf16_f32 v242, v242, v243
  v_cvt_pk_bf16_f32 v244, v244, v245
  v_cvt_pk_bf16_f32 v246, v246, v247
  v_accvgpr_write_b32 a8, v240
  v_accvgpr_write_b32 a9, v242
  v_accvgpr_write_b32 a10, v244
  v_accvgpr_write_b32 a11, v246
  v_lshlrev_b32 v240, 16, v236
  v_and_b32 v241, s38, v236
  v_lshlrev_b32 v242, 16, v237
  v_and_b32 v243, s38, v237
  v_lshlrev_b32 v244, 16, v238
  v_and_b32 v245, s38, v238
  v_lshlrev_b32 v246, 16, v239
  v_and_b32 v247, s38, v239
  v_pk_mul_f32 v[240:241], v[240:241], s[36:37] op_sel_hi:[1,0]
  v_pk_mul_f32 v[242:243], v[242:243], s[36:37] op_sel_hi:[1,0]
  v_pk_mul_f32 v[244:245], v[244:245], s[36:37] op_sel_hi:[1,0]
  v_pk_mul_f32 v[246:247], v[246:247], s[36:37] op_sel_hi:[1,0]
  v_cvt_pk_bf16_f32 v240, v240, v241
  v_cvt_pk_bf16_f32 v242, v242, v243
  v_cvt_pk_bf16_f32 v244, v244, v245
  v_cvt_pk_bf16_f32 v246, v246, v247
  v_accvgpr_write_b32 a12, v240
  v_accvgpr_write_b32 a13, v242
  v_accvgpr_write_b32 a14, v244
  v_accvgpr_write_b32 a15, v246
  s_nop 1
  s_mov_b64 exec, 0
  s_cmp_eq_u32 s3, 0
  s_cbranch_scc1 L_isl1
  s_cmp_eq_u32 s3, 1
  s_cbranch_scc1 L_isl2
  s_cmp_eq_u32 s3, 2
  s_cbranch_scc1 L_isl3
  s_cmp_eq_u32 s3, 3
  s_cbranch_scc1 L_isl4
L_retA:
  s_cmp_eq_u32 s96, 1
  s_cbranch_scc1 L_retAx1
  s_mov_b64 exec, -1
  s_waitcnt vmcnt(8)
  buffer_load_dwordx4 v0, s[16:19], s35 offen offset:1024 nt lds
  s_waitcnt vmcnt(8)
  s_barrier
  ds_read_b128 a[96:99], v4 offset:0
  ds_read_b128 a[100:103], v4 offset:256
  ds_read_b128 a[104:107], v4 offset:512
  ds_read_b128 a[108:111], v4 offset:768
  ds_read_b128 a[112:115], v4 offset:8192
  ds_read_b128 a[116:119], v4 offset:8448
  ds_read_b128 a[120:123], v4 offset:8704
  ds_read_b128 a[124:127], v4 offset:8960
  s_waitcnt lgkmcnt(7)
  v_mfma_f32_16x16x32_bf16 v[36:39], a[96:99], a[0:3], 0
  s_waitcnt lgkmcnt(6)
  v_mfma_f32_16x16x32_bf16 v[36:39], a[100:103], a[4:7], v[36:39]
  s_waitcnt lgkmcnt(5)
  v_mfma_f32_16x16x32_bf16 v[36:39], a[104:107], a[8:11], v[36:39]
  s_waitcnt lgkmcnt(4)
  v_mfma_f32_16x16x32_bf16 v[36:39], a[108:111], a[12:15], v[36:39]
  s_waitcnt lgkmcnt(3)
  v_mfma_f32_16x16x32_bf16 v[32:35], a[112:115], a[0:3], 0
  s_waitcnt lgkmcnt(2)
  v_mfma_f32_16x16x32_bf16 v[32:35], a[116:119], a[4:7], v[32:35]
  s_waitcnt lgkmcnt(1)
  v_mfma_f32_16x16x32_bf16 v[32:35], a[120:123], a[8:11], v[32:35]
  s_waitcnt lgkmcnt(0)
  v_mfma_f32_16x16x32_bf16 v[32:35], a[124:127], a[12:15], v[32:35]
  s_nop 7
  v_max3_f32 v8, v36, v37, v38
  v_max3_f32 v8, v39, v32, v8
  v_max3_f32 v8, v33, v34, v8
  v_max_f32 v8, v35, v8
  v_mov_b32 v9, v8
  s_nop 1
  v_permlane16_swap_b32 v8, v9
  v_max_f32 v8, v8, v9
  v_mov_b32 v9, v8
  s_nop 1
  v_permlane32_swap_b32 v8, v9
  v_max_f32 v8, v8, v9
  v_sub_f32 v10, 0, v8
  v_add_f32 v36, v36, v10
  v_add_f32 v37, v37, v10
  v_add_f32 v38, v38, v10
  v_add_f32 v39, v39, v10
  v_add_f32 v32, v32, v10
  v_add_f32 v33, v33, v10
  v_add_f32 v34, v34, v10
  v_add_f32 v35, v35, v10
  v_exp_f32 v36, v36
  v_exp_f32 v37, v37
  v_exp_f32 v38, v38
  v_exp_f32 v39, v39
  v_exp_f32 v32, v32
  buffer_load_dwordx4 v0, s[16:19], s35 offen offset:2048 nt lds
  v_exp_f32 v33, v33
  v_exp_f32 v34, v34
  v_exp_f32 v35, v35
  v_mov_b32 v11, v10
  v_mov_b32 v12, v10
  v_mov_b32 v13, v10
  v_cvt_pk_bf16_f32 v36, v36, v37
  v_cvt_pk_bf16_f32 v37, v38, v39
  v_cvt_pk_bf16_f32 v38, v32, v33
  v_cvt_pk_bf16_f32 v39, v34, v35
  s_mov_b64 exec, 0
  s_cmp_eq_u32 s3, 0
  s_cbranch_scc1 L_isl5
  s_cmp_eq_u32 s3, 1
  s_cbranch_scc1 L_isl6
L_retB:
  s_cmp_eq_u32 s96, 1
  s_cbranch_scc1 L_retBx1
  s_mov_b64 exec, -1
  s_waitcnt vmcnt(8)
  buffer_load_dwordx4 v0, s[16:19], s35 offen offset:3072 nt lds
  s_waitcnt vmcnt(7)
  s_add_u32 m0, s32, 114688
  s_xor_b32 s35, s34, 49152
  buffer_load_dwordx4 v0, s[16:19], s35 offen nt lds
  s_waitcnt vmcnt(7)
  ds_read_b128 v[224:227], v3 offset:16384
  ds_read_b128 v[228:231], v3 offset:16640
  ds_read_b128 v[232:235], v3 offset:16896
  ds_read_b128 v[236:239], v3 offset:17152
  s_waitcnt lgkmcnt(0)
  v_lshlrev_b32 v240, 16, v224
  v_and_b32 v241, s38, v224
  v_lshlrev_b32 v242, 16, v225
  v_and_b32 v243, s38, v225
  v_lshlrev_b32 v244, 16, v226
  v_and_b32 v245, s38, v226
  v_lshlrev_b32 v246, 16, v227
  v_and_b32 v247, s38, v227
  v_pk_mul_f32 v[240:241], v[240:241], s[36:37] op_sel_hi:[1,0]
  v_pk_mul_f32 v[242:243], v[242:243], s[36:37] op_sel_hi:[1,0]
  v_pk_mul_f32 v[244:245], v[244:245], s[36:37] op_sel_hi:[1,0]
  v_pk_mul_f32 v[246:247], v[246:247], s[36:37] op_sel_hi:[1,0]
  v_cvt_pk_bf16_f32 v240, v240, v241
  v_cvt_pk_bf16_f32 v242, v242, v243
  v_cvt_pk_bf16_f32 v244, v244, v245
  v_cvt_pk_bf16_f32 v246, v246, v247
  v_accvgpr_write_b32 a16, v240
  v_accvgpr_write_b32 a17, v242
  v_accvgpr_write_b32 a18, v244
  v_accvgpr_write_b32 a19, v246
  v_lshlrev_b32 v240, 16, v228
  v_and_b32 v241, s38, v228
  v_lshlrev_b32 v242, 16, v229
  v_and_b32 v243, s38, v229
  v_lshlrev_b32 v244, 16, v230
  v_and_b32 v245, s38, v230
  v_lshlrev_b32 v246, 16, v231
  v_and_b32 v247, s38, v231
  v_pk_mul_f32 v[240:241], v[240:241], s[36:37] op_sel_hi:[1,0]
  v_pk_mul_f32 v[242:243], v[242:243], s[36:37] op_sel_hi:[1,0]
  v_pk_mul_f32 v[244:245], v[244:245], s[36:37] op_sel_hi:[1,0]
  v_pk_mul_f32 v[246:247], v[246:247], s[36:37] op_sel_hi:[1,0]
  v_cvt_pk_bf16_f32 v240, v240, v241
  v_cvt_pk_bf16_f32 v242, v242, v243
  v_cvt_pk_bf16_f32 v244, v244, v245
  v_cvt_pk_bf16_f32 v246, v246, v247
  v_accvgpr_write_b32 a20, v240
  v_accvgpr_write_b32 a21, v242
  v_accvgpr_write_b32 a22, v244
  v_accvgpr_write_b32 a23, v246
  v_lshlrev_b32 v240, 16, v232
  v_and_b32 v241, s38, v232
  v_lshlrev_b32 v242, 16, v233
  v_and_b32 v243, s38, v233
  v_lshlrev_b32 v244, 16, v234
  v_and_b32 v245, s38, v234
  v_lshlrev_b32 v246, 16, v235
  v_and_b32 v247, s38, v235
  v_pk_mul_f32 v[240:241], v[240:241], s[36:37] op_sel_hi:[1,0]
  v_pk_mul_f32 v[242:243], v[242:243], s[36:37] op_sel_hi:[1,0]
  v_pk_mul_f32 v[244:245], v[244:245], s[36:37] op_sel_hi:[1,0]
  v_pk_mul_f32 v[246:247], v[246:247], s[36:37] op_sel_hi:[1,0]
  v_cvt_pk_bf16_f32 v240, v240, v241
  v_cvt_pk_bf16_f32 v242, v242, v243
  v_cvt_pk_bf16_f32 v244, v244, v245
  v_cvt_pk_bf16_f32 v246, v246, v247
  v_accvgpr_write_b32 a24, v240
  v_accvgpr_write_b32 a25, v242
  v_accvgpr_write_b32 a26, v244
  v_accvgpr_write_b32 a27, v246
  v_lshlrev_b32 v240, 16, v236
  v_and_b32 v241, s38, v236
  v_lshlrev_b32 v242, 16, v237
  v_and_b32 v243, s38, v237
  v_lshlrev_b32 v244, 16, v238
  v_and_b32 v245, s38, v238
  v_lshlrev_b32 v246, 16, v239
  v_and_b32 v247, s38, v239
  v_pk_mul_f32 v[240:241], v[240:241], s[36:37] op_sel_hi:[1,0]
  v_pk_mul_f32 v[242:243], v[242:243], s[36:37] op_sel_hi:[1,0]
  v_pk_mul_f32 v[244:245], v[244:245], s[36:37] op_sel_hi:[1,0]
  v_pk_mul_f32 v[246:247], v[246:247], s[36:37] op_sel_hi:[1,0]
  v_cvt_pk_bf16_f32 v240, v240, v241
  v_cvt_pk_bf16_f32 v242, v242, v243
  v_cvt_pk_bf16_f32 v244, v244, v245
  v_cvt_pk_bf16_f32 v246, v246, v247
  v_accvgpr_write_b32 a28, v240
  v_accvgpr_write_b32 a29, v242
  v_accvgpr_write_b32 a30, v244
  v_accvgpr_write_b32 a31, v246
  s_nop 1
  v_mfma_f32_16x16x32_bf16 v[40:43], a[96:99], a[16:19], 0
  buffer_load_dwordx4 v0, s[16:19], s35 offen offset:1024 nt lds
  v_mfma_f32_16x16x32_bf16 v[40:43], a[100:103], a[20:23], v[40:43]
  v_mfma_f32_16x16x32_bf16 v[40:43], a[104:107], a[24:27], v[40:43]
  v_mfma_f32_16x16x32_bf16 v[40:43], a[108:111], a[28:31], v[40:43]
  v_mfma_f32_16x16x32_bf16 v[44:47], a[112:115], a[16:19], 0
  v_mfma_f32_16x16x32_bf16 v[44:47], a[116:119], a[20:23], v[44:47]
  v_mfma_f32_16x16x32_bf16 v[44:47], a[120:123], a[24:27], v[44:47]
  v_mfma_f32_16x16x32_bf16 v[44:47], a[124:127], a[28:31], v[44:47]
  s_nop 7
  v_max3_f32 v8, v40, v41, v42
  v_max3_f32 v8, v43, v44, v8
  v_max3_f32 v8, v45, v46, v8
  v_max_f32 v8, v47, v8
  v_mov_b32 v9, v8
  s_nop 1
  v_permlane16_swap_b32 v8, v9
  v_max_f32 v8, v8, v9
  v_mov_b32 v9, v8
  s_nop 1
  v_permlane32_swap_b32 v8, v9
  v_max_f32 v8, v8, v9
  v_sub_f32 v14, 0, v8
  v_add_f32 v40, v40, v14
  v_add_f32 v41, v41, v14
  v_add_f32 v42, v42, v14
  v_add_f32 v43, v43, v14
  v_add_f32 v44, v44, v14
  v_add_f32 v45, v45, v14
  v_add_f32 v46, v46, v14
  v_add_f32 v47, v47, v14
  v_exp_f32 v40, v40
  v_exp_f32 v41, v41
  v_exp_f32 v42, v42
  v_exp_f32 v43, v43
  v_exp_f32 v44, v44
  v_exp_f32 v45, v45
  v_exp_f32 v46, v46
  v_exp_f32 v47, v47
  v_mov_b32 v15, v14
  v_mov_b32 v16, v14
  v_mov_b32 v17, v14
  v_cvt_pk_bf16_f32 v40, v40, v41
  v_cvt_pk_bf16_f32 v41, v42, v43
  v_cvt_pk_bf16_f32 v42, v44, v45
  v_cvt_pk_bf16_f32 v43, v46, v47
  s_waitcnt vmcnt(7)
  buffer_load_dwordx4 v0, s[16:19], s35 offen offset:2048 nt lds
  s_waitcnt vmcnt(7)
  s_barrier
  ds_read_b64_tr_b16 a[128:129], v5 offset:2048
  ds_read_b64_tr_b16 a[130:131], v5 offset:10240
  ds_read_b64_tr_b16 a[132:133], v6 offset:2048
  ds_read_b64_tr_b16 a[134:135], v6 offset:10240
  ds_read_b64_tr_b16 a[136:137], v5 offset:2304
  ds_read_b64_tr_b16 a[138:139], v5 offset:10496
  ds_read_b64_tr_b16 a[140:141], v6 offset:2304
  ds_read_b64_tr_b16 a[142:143], v6 offset:10496
  ds_read_b64_tr_b16 a[144:145], v5 offset:2560
  ds_read_b64_tr_b16 a[146:147], v5 offset:10752
  ds_read_b64_tr_b16 a[148:149], v6 offset:2560
  ds_read_b64_tr_b16 a[150:151], v6 offset:10752
  ds_read_b64_tr_b16 a[152:153], v5 offset:2816
  ds_read_b64_tr_b16 a[154:155], v5 offset:11008
  ds_read_b64_tr_b16 a[156:157], v6 offset:2816
  ds_read_b64_tr_b16 a[158:159], v6 offset:11008
  s_waitcnt lgkmcnt(14)
  v_mfma_f32_16x16x32_bf16 v[64:67], a[128:131], v[36:39], 0
  s_waitcnt lgkmcnt(12)
  v_mfma_f32_16x16x32_bf16 v[68:71], a[132:135], v[36:39], 0
  s_waitcnt lgkmcnt(10)
  v_mfma_f32_16x16x32_bf16 v[72:75], a[136:139], v[36:39], 0
  s_waitcnt lgkmcnt(8)
  v_mfma_f32_16x16x32_bf16 v[76:79], a[140:143], v[36:39], 0
  s_waitcnt lgkmcnt(6)
  v_mfma_f32_16x16x32_bf16 v[80:83], a[144:147], v[36:39], 0
  s_waitcnt lgkmcnt(4)
  v_mfma_f32_16x16x32_bf16 v[84:87], a[148:151], v[36:39], 0
  s_waitcnt lgkmcnt(2)
  v_mfma_f32_16x16x32_bf16 v[88:91], a[152:155], v[36:39], 0
  s_waitcnt lgkmcnt(0)
  v_mfma_f32_16x16x32_bf16 v[92:95], a[156:159], v[36:39], 0
  s_waitcnt vmcnt(6)
  buffer_load_dwordx4 v0, s[16:19], s35 offen offset:3072 nt lds
  s_waitcnt vmcnt(6)
  s_add_u32 m0, s32, 131072
  s_xor_b32 s35, s34, 65536
  buffer_load_dwordx4 v0, s[16:19], s35 offen nt lds
  s_waitcnt vmcnt(6)
  buffer_load_dwordx4 v0, s[16:19], s35 offen offset:1024 nt lds
  s_waitcnt vmcnt(6)
  ds_read_b128 v[224:227], v3 offset:32768
  ds_read_b128 v[228:231], v3 offset:33024
  ds_read_b128 v[232:235], v3 offset:33280
  ds_read_b128 v[236:239], v3 offset:33536
  v_smfmac_f32_16x16x64_bf16 a[192:195], a[204:207], v[36:43], v7
  v_mfma_f32_16x16x32_bf16 v[96:99], a[128:131], v[40:43], 0
  v_mfma_f32_16x16x32_bf16 v[100:103], a[132:135], v[40:43], 0
  v_mfma_f32_16x16x32_bf16 v[104:107], a[136:139], v[40:43], 0
  v_mfma_f32_16x16x32_bf16 v[108:111], a[140:143], v[40:43], 0
  v_mfma_f32_16x16x32_bf16 v[112:115], a[144:147], v[40:43], 0
  v_mfma_f32_16x16x32_bf16 v[116:119], a[148:151], v[40:43], 0
  v_mfma_f32_16x16x32_bf16 v[120:123], a[152:155], v[40:43], 0
  v_mfma_f32_16x16x32_bf16 v[124:127], a[156:159], v[40:43], 0
  s_waitcnt lgkmcnt(0)
  v_lshlrev_b32 v240, 16, v224
  v_and_b32 v241, s38, v224
  v_lshlrev_b32 v242, 16, v225
  v_and_b32 v243, s38, v225
  v_lshlrev_b32 v244, 16, v226
  v_and_b32 v245, s38, v226
  v_lshlrev_b32 v246, 16, v227
  v_and_b32 v247, s38, v227
  v_pk_mul_f32 v[240:241], v[240:241], s[36:37] op_sel_hi:[1,0]
  v_pk_mul_f32 v[242:243], v[242:243], s[36:37] op_sel_hi:[1,0]
  v_pk_mul_f32 v[244:245], v[244:245], s[36:37] op_sel_hi:[1,0]
L_isl1:
  s_cbranch_execz L_retA
  v_pk_mul_f32 v[246:247], v[246:247], s[36:37] op_sel_hi:[1,0]
  v_cvt_pk_bf16_f32 v240, v240, v241
  v_cvt_pk_bf16_f32 v242, v242, v243
  v_cvt_pk_bf16_f32 v244, v244, v245
  v_cvt_pk_bf16_f32 v246, v246, v247
  v_accvgpr_write_b32 a32, v240
  v_accvgpr_write_b32 a33, v242
  v_accvgpr_write_b32 a34, v244
  v_accvgpr_write_b32 a35, v246
  v_lshlrev_b32 v240, 16, v228
  v_and_b32 v241, s38, v228
  v_lshlrev_b32 v242, 16, v229
  v_and_b32 v243, s38, v229
  v_lshlrev_b32 v244, 16, v230
  v_and_b32 v245, s38, v230
  v_lshlrev_b32 v246, 16, v231
  v_and_b32 v247, s38, v231
  v_pk_mul_f32 v[240:241], v[240:241], s[36:37] op_sel_hi:[1,0]
  v_pk_mul_f32 v[242:243], v[242:243], s[36:37] op_sel_hi:[1,0]
  v_pk_mul_f32 v[244:245], v[244:245], s[36:37] op_sel_hi:[1,0]
  v_pk_mul_f32 v[246:247], v[246:247], s[36:37] op_sel_hi:[1,0]
  v_cvt_pk_bf16_f32 v240, v240, v241
  v_cvt_pk_bf16_f32 v242, v242, v243
  v_cvt_pk_bf16_f32 v244, v244, v245
  v_cvt_pk_bf16_f32 v246, v246, v247
  v_accvgpr_write_b32 a36, v240
  v_accvgpr_write_b32 a37, v242
  v_accvgpr_write_b32 a38, v244
  v_accvgpr_write_b32 a39, v246
  v_lshlrev_b32 v240, 16, v232
  v_and_b32 v241, s38, v232
  v_lshlrev_b32 v242, 16, v233
  v_and_b32 v243, s38, v233
  v_lshlrev_b32 v244, 16, v234
  v_and_b32 v245, s38, v234
  v_lshlrev_b32 v246, 16, v235
  buffer_load_dwordx4 v0, s[16:19], s35 offen offset:2048 nt lds
  v_and_b32 v247, s38, v235
  v_pk_mul_f32 v[240:241], v[240:241], s[36:37] op_sel_hi:[1,0]
  v_pk_mul_f32 v[242:243], v[242:243], s[36:37] op_sel_hi:[1,0]
  v_pk_mul_f32 v[244:245], v[244:245], s[36:37] op_sel_hi:[1,0]
  v_pk_mul_f32 v[246:247], v[246:247], s[36:37] op_sel_hi:[1,0]
  v_cvt_pk_bf16_f32 v240, v240, v241
  v_cvt_pk_bf16_f32 v242, v242, v243
  v_cvt_pk_bf16_f32 v244, v244, v245
  v_cvt_pk_bf16_f32 v246, v246, v247
  v_accvgpr_write_b32 a40, v240
  v_accvgpr_write_b32 a41, v242
  v_accvgpr_write_b32 a42, v244
  v_accvgpr_write_b32 a43, v246
  v_lshlrev_b32 v240, 16, v236
  v_and_b32 v241, s38, v236
  v_lshlrev_b32 v242, 16, v237
  v_and_b32 v243, s38, v237
  v_lshlrev_b32 v244, 16, v238
  v_and_b32 v245, s38, v238
  v_lshlrev_b32 v246, 16, v239
  v_and_b32 v247, s38, v239
  v_pk_mul_f32 v[240:241], v[240:241], s[36:37] op_sel_hi:[1,0]
  v_pk_mul_f32 v[242:243], v[242:243], s[36:37] op_sel_hi:[1,0]
  v_pk_mul_f32 v[244:245], v[244:245], s[36:37] op_sel_hi:[1,0]
  v_pk_mul_f32 v[246:247], v[246:247], s[36:37] op_sel_hi:[1,0]
  v_cvt_pk_bf16_f32 v240, v240, v241
  v_cvt_pk_bf16_f32 v242, v242, v243
  v_cvt_pk_bf16_f32 v244, v244, v245
  v_cvt_pk_bf16_f32 v246, v246, v247
  v_accvgpr_write_b32 a44, v240
  v_accvgpr_write_b32 a45, v242
  v_accvgpr_write_b32 a46, v244
  v_accvgpr_write_b32 a47, v246
  s_nop 1
  v_mfma_f32_16x16x32_bf16 v[52:55], a[96:99], a[32:35], 0
  v_mfma_f32_16x16x32_bf16 v[52:55], a[100:103], a[36:39], v[52:55]
  v_mfma_f32_16x16x32_bf16 v[52:55], a[104:107], a[40:43], v[52:55]
  v_mfma_f32_16x16x32_bf16 v[52:55], a[108:111], a[44:47], v[52:55]
  v_mfma_f32_16x16x32_bf16 v[48:51], a[112:115], a[32:35], 0
  v_mfma_f32_16x16x32_bf16 v[48:51], a[116:119], a[36:39], v[48:51]
  v_mfma_f32_16x16x32_bf16 v[48:51], a[120:123], a[40:43], v[48:51]
  v_mfma_f32_16x16x32_bf16 v[48:51], a[124:127], a[44:47], v[48:51]
  s_nop 7
  v_max3_f32 v8, v52, v53, v54
  v_max3_f32 v8, v55, v48, v8
  v_max3_f32 v8, v49, v50, v8
  v_max_f32 v8, v51, v8
  v_mov_b32 v9, v8
  s_nop 1
  v_permlane16_swap_b32 v8, v9
  v_max_f32 v8, v8, v9
  v_mov_b32 v9, v8
  s_nop 1
  v_permlane32_swap_b32 v8, v9
  buffer_load_dwordx4 v0, s[16:19], s35 offen offset:3072 nt lds
  v_max_f32 v8, v8, v9
  v_sub_f32 v18, 0, v8
  v_add_f32 v52, v52, v18
  v_add_f32 v53, v53, v18
  v_add_f32 v54, v54, v18
  v_add_f32 v55, v55, v18
  v_add_f32 v48, v48, v18
  v_add_f32 v49, v49, v18
  v_add_f32 v50, v50, v18
  v_add_f32 v51, v51, v18
  v_exp_f32 v52, v52
  v_exp_f32 v53, v53
  v_exp_f32 v54, v54
  v_exp_f32 v55, v55
  v_exp_f32 v48, v48
  v_exp_f32 v49, v49
  v_exp_f32 v50, v50
  v_exp_f32 v51, v51
  v_mov_b32 v19, v18
  v_mov_b32 v20, v18
  v_mov_b32 v21, v18
  v_cvt_pk_bf16_f32 v52, v52, v53
  v_cvt_pk_bf16_f32 v53, v54, v55
  v_cvt_pk_bf16_f32 v54, v48, v49
  v_cvt_pk_bf16_f32 v55, v50, v51
  s_waitcnt vmcnt(5)
  s_add_u32 m0, s32, 147456
  s_xor_b32 s35, s34, 81920
  buffer_load_dwordx4 v0, s[16:19], s35 offen nt lds
  s_waitcnt vmcnt(5)
  ds_read_b128 v[224:227], v3 offset:49152
  ds_read_b128 v[228:231], v3 offset:49408
  ds_read_b128 v[232:235], v3 offset:49664
  ds_read_b128 v[236:239], v3 offset:49920
  v_mfma_f32_16x16x32_bf16 v[128:131], a[128:131], v[52:55], 0
  v_mfma_f32_16x16x32_bf16 v[132:135], a[132:135], v[52:55], 0
  v_mfma_f32_16x16x32_bf16 v[136:139], a[136:139], v[52:55], 0
  v_mfma_f32_16x16x32_bf16 v[140:143], a[140:143], v[52:55], 0
  v_mfma_f32_16x16x32_bf16 v[144:147], a[144:147], v[52:55], 0
  v_mfma_f32_16x16x32_bf16 v[148:151], a[148:151], v[52:55], 0
  v_mfma_f32_16x16x32_bf16 v[152:155], a[152:155], v[52:55], 0
  v_mfma_f32_16x16x32_bf16 v[156:159], a[156:159], v[52:55], 0
  s_waitcnt lgkmcnt(0)
  v_lshlrev_b32 v240, 16, v224
  v_and_b32 v241, s38, v224
  v_lshlrev_b32 v242, 16, v225
  v_and_b32 v243, s38, v225
  v_lshlrev_b32 v244, 16, v226
  v_and_b32 v245, s38, v226
  v_lshlrev_b32 v246, 16, v227
  v_and_b32 v247, s38, v227
  v_pk_mul_f32 v[240:241], v[240:241], s[36:37] op_sel_hi:[1,0]
  v_pk_mul_f32 v[242:243], v[242:243], s[36:37] op_sel_hi:[1,0]
  v_pk_mul_f32 v[244:245], v[244:245], s[36:37] op_sel_hi:[1,0]
  v_pk_mul_f32 v[246:247], v[246:247], s[36:37] op_sel_hi:[1,0]
  v_cvt_pk_bf16_f32 v240, v240, v241
  v_cvt_pk_bf16_f32 v242, v242, v243
  v_cvt_pk_bf16_f32 v244, v244, v245
  v_cvt_pk_bf16_f32 v246, v246, v247
  v_accvgpr_write_b32 a48, v240
  v_accvgpr_write_b32 a49, v242
  v_accvgpr_write_b32 a50, v244
  v_accvgpr_write_b32 a51, v246
  v_lshlrev_b32 v240, 16, v228
  v_and_b32 v241, s38, v228
  v_lshlrev_b32 v242, 16, v229
  v_and_b32 v243, s38, v229
  v_lshlrev_b32 v244, 16, v230
  v_and_b32 v245, s38, v230
  v_lshlrev_b32 v246, 16, v231
  v_and_b32 v247, s38, v231
  v_pk_mul_f32 v[240:241], v[240:241], s[36:37] op_sel_hi:[1,0]
  v_pk_mul_f32 v[242:243], v[242:243], s[36:37] op_sel_hi:[1,0]
  v_pk_mul_f32 v[244:245], v[244:245], s[36:37] op_sel_hi:[1,0]
  v_pk_mul_f32 v[246:247], v[246:247], s[36:37] op_sel_hi:[1,0]
  v_cvt_pk_bf16_f32 v240, v240, v241
  v_cvt_pk_bf16_f32 v242, v242, v243
  v_cvt_pk_bf16_f32 v244, v244, v245
  v_cvt_pk_bf16_f32 v246, v246, v247
  v_accvgpr_write_b32 a52, v240
  v_accvgpr_write_b32 a53, v242
  v_accvgpr_write_b32 a54, v244
  v_accvgpr_write_b32 a55, v246
  v_lshlrev_b32 v240, 16, v232
  v_and_b32 v241, s38, v232
  v_lshlrev_b32 v242, 16, v233
  v_and_b32 v243, s38, v233
  v_lshlrev_b32 v244, 16, v234
  v_and_b32 v245, s38, v234
  v_lshlrev_b32 v246, 16, v235
  v_and_b32 v247, s38, v235
  v_pk_mul_f32 v[240:241], v[240:241], s[36:37] op_sel_hi:[1,0]
  v_pk_mul_f32 v[242:243], v[242:243], s[36:37] op_sel_hi:[1,0]
  v_pk_mul_f32 v[244:245], v[244:245], s[36:37] op_sel_hi:[1,0]
  buffer_load_dwordx4 v0, s[16:19], s35 offen offset:1024 nt lds
  v_pk_mul_f32 v[246:247], v[246:247], s[36:37] op_sel_hi:[1,0]
  v_cvt_pk_bf16_f32 v240, v240, v241
  v_cvt_pk_bf16_f32 v242, v242, v243
  v_cvt_pk_bf16_f32 v244, v244, v245
  v_cvt_pk_bf16_f32 v246, v246, v247
  v_accvgpr_write_b32 a56, v240
  v_accvgpr_write_b32 a57, v242
  v_accvgpr_write_b32 a58, v244
  v_accvgpr_write_b32 a59, v246
  v_lshlrev_b32 v240, 16, v236
  v_and_b32 v241, s38, v236
  v_lshlrev_b32 v242, 16, v237
  v_and_b32 v243, s38, v237
  v_lshlrev_b32 v244, 16, v238
  v_and_b32 v245, s38, v238
  v_lshlrev_b32 v246, 16, v239
  v_and_b32 v247, s38, v239
  v_pk_mul_f32 v[240:241], v[240:241], s[36:37] op_sel_hi:[1,0]
  v_pk_mul_f32 v[242:243], v[242:243], s[36:37] op_sel_hi:[1,0]
  v_pk_mul_f32 v[244:245], v[244:245], s[36:37] op_sel_hi:[1,0]
  v_pk_mul_f32 v[246:247], v[246:247], s[36:37] op_sel_hi:[1,0]
  v_cvt_pk_bf16_f32 v240, v240, v241
  v_cvt_pk_bf16_f32 v242, v242, v243
  v_cvt_pk_bf16_f32 v244, v244, v245
  v_cvt_pk_bf16_f32 v246, v246, v247
  v_accvgpr_write_b32 a60, v240
  v_accvgpr_write_b32 a61, v242
  v_accvgpr_write_b32 a62, v244
  v_accvgpr_write_b32 a63, v246
  s_nop 1
  v_mfma_f32_16x16x32_bf16 v[56:59], a[96:99], a[48:51], 0
  v_mfma_f32_16x16x32_bf16 v[56:59], a[100:103], a[52:55], v[56:59]
  v_mfma_f32_16x16x32_bf16 v[56:59], a[104:107], a[56:59], v[56:59]
  v_mfma_f32_16x16x32_bf16 v[56:59], a[108:111], a[60:63], v[56:59]
  v_mfma_f32_16x16x32_bf16 v[60:63], a[112:115], a[48:51], 0
  v_mfma_f32_16x16x32_bf16 v[60:63], a[116:119], a[52:55], v[60:63]
  v_mfma_f32_16x16x32_bf16 v[60:63], a[120:123], a[56:59], v[60:63]
  v_mfma_f32_16x16x32_bf16 v[60:63], a[124:127], a[60:63], v[60:63]
  s_nop 7
  v_max3_f32 v8, v56, v57, v58
  v_max3_f32 v8, v59, v60, v8
  v_max3_f32 v8, v61, v62, v8
  v_max_f32 v8, v63, v8
  v_mov_b32 v9, v8
  s_nop 1
  v_permlane16_swap_b32 v8, v9
  v_max_f32 v8, v8, v9
  v_mov_b32 v9, v8
  s_nop 1
  v_permlane32_swap_b32 v8, v9
  v_max_f32 v8, v8, v9
  v_sub_f32 v22, 0, v8
  v_add_f32 v56, v56, v22
  v_add_f32 v57, v57, v22
  buffer_load_dwordx4 v0, s[16:19], s35 offen offset:2048 nt lds
  v_add_f32 v58, v58, v22
  v_add_f32 v59, v59, v22
  v_add_f32 v60, v60, v22
  v_add_f32 v61, v61, v22
  v_add_f32 v62, v62, v22
  v_add_f32 v63, v63, v22
  v_exp_f32 v56, v56
  v_exp_f32 v57, v57
  v_exp_f32 v58, v58
  v_exp_f32 v59, v59
  v_exp_f32 v60, v60
  v_exp_f32 v61, v61
  v_exp_f32 v62, v62
  v_exp_f32 v63, v63
  v_mov_b32 v23, v22
  v_mov_b32 v24, v22
  v_mov_b32 v25, v22
  v_cvt_pk_bf16_f32 v56, v56, v57
  v_cvt_pk_bf16_f32 v57, v58, v59
  v_cvt_pk_bf16_f32 v58, v60, v61
  v_cvt_pk_bf16_f32 v59, v62, v63
  s_waitcnt vmcnt(4)
  buffer_load_dwordx4 v0, s[16:19], s35 offen offset:3072 nt lds
  s_waitcnt vmcnt(4)
  v_add_u32 v3, 0x10000, v3
  ds_read_b128 v[224:227], v3 offset:0
  ds_read_b128 v[228:231], v3 offset:256
  ds_read_b128 v[232:235], v3 offset:512
  ds_read_b128 v[236:239], v3 offset:768
  v_smfmac_f32_16x16x64_bf16 a[196:199], a[204:207], v[52:59], v7
  v_mfma_f32_16x16x32_bf16 v[160:163], a[128:131], v[56:59], 0
  v_mfma_f32_16x16x32_bf16 v[164:167], a[132:135], v[56:59], 0
  v_mfma_f32_16x16x32_bf16 v[168:171], a[136:139], v[56:59], 0
  v_mfma_f32_16x16x32_bf16 v[172:175], a[140:143], v[56:59], 0
  v_mfma_f32_16x16x32_bf16 v[176:179], a[144:147], v[56:59], 0
  v_mfma_f32_16x16x32_bf16 v[180:183], a[148:151], v[56:59], 0
  v_mfma_f32_16x16x32_bf16 v[184:187], a[152:155], v[56:59], 0
  v_mfma_f32_16x16x32_bf16 v[188:191], a[156:159], v[56:59], 0
  s_waitcnt lgkmcnt(0)
  v_lshlrev_b32 v240, 16, v224
  v_and_b32 v241, s38, v224
  v_lshlrev_b32 v242, 16, v225
  v_and_b32 v243, s38, v225
  v_lshlrev_b32 v244, 16, v226
  v_and_b32 v245, s38, v226
  v_lshlrev_b32 v246, 16, v227
  v_and_b32 v247, s38, v227
  v_pk_mul_f32 v[240:241], v[240:241], s[36:37] op_sel_hi:[1,0]
  v_pk_mul_f32 v[242:243], v[242:243], s[36:37] op_sel_hi:[1,0]
  v_pk_mul_f32 v[244:245], v[244:245], s[36:37] op_sel_hi:[1,0]
  v_pk_mul_f32 v[246:247], v[246:247], s[36:37] op_sel_hi:[1,0]
  v_cvt_pk_bf16_f32 v240, v240, v241
  v_cvt_pk_bf16_f32 v242, v242, v243
  v_cvt_pk_bf16_f32 v244, v244, v245
  v_cvt_pk_bf16_f32 v246, v246, v247
  v_accvgpr_write_b32 a64, v240
  v_accvgpr_write_b32 a65, v242
  v_accvgpr_write_b32 a66, v244
  v_accvgpr_write_b32 a67, v246
  v_lshlrev_b32 v240, 16, v228
  v_and_b32 v241, s38, v228
  v_lshlrev_b32 v242, 16, v229
  v_and_b32 v243, s38, v229
  v_lshlrev_b32 v244, 16, v230
  v_and_b32 v245, s38, v230
  v_lshlrev_b32 v246, 16, v231
  v_and_b32 v247, s38, v231
  v_pk_mul_f32 v[240:241], v[240:241], s[36:37] op_sel_hi:[1,0]
  v_pk_mul_f32 v[242:243], v[242:243], s[36:37] op_sel_hi:[1,0]
  v_pk_mul_f32 v[244:245], v[244:245], s[36:37] op_sel_hi:[1,0]
  v_pk_mul_f32 v[246:247], v[246:247], s[36:37] op_sel_hi:[1,0]
  v_cvt_pk_bf16_f32 v240, v240, v241
  v_cvt_pk_bf16_f32 v242, v242, v243
  v_cvt_pk_bf16_f32 v244, v244, v245
  v_cvt_pk_bf16_f32 v246, v246, v247
  v_accvgpr_write_b32 a68, v240
  v_accvgpr_write_b32 a69, v242
  v_accvgpr_write_b32 a70, v244
  v_accvgpr_write_b32 a71, v246
  v_lshlrev_b32 v240, 16, v232
  v_and_b32 v241, s38, v232
  v_lshlrev_b32 v242, 16, v233
  v_and_b32 v243, s38, v233
  v_lshlrev_b32 v244, 16, v234
  v_and_b32 v245, s38, v234
  s_add_u32 m0, s32, 16384
  s_xor_b32 s35, s33, 8192
  buffer_load_dwordx4 v2, s[20:23], s35 offen nt lds
  v_lshlrev_b32 v246, 16, v235
  v_and_b32 v247, s38, v235
  v_pk_mul_f32 v[240:241], v[240:241], s[36:37] op_sel_hi:[1,0]
  v_pk_mul_f32 v[242:243], v[242:243], s[36:37] op_sel_hi:[1,0]
  v_pk_mul_f32 v[244:245], v[244:245], s[36:37] op_sel_hi:[1,0]
  v_pk_mul_f32 v[246:247], v[246:247], s[36:37] op_sel_hi:[1,0]
  v_cvt_pk_bf16_f32 v240, v240, v241
  v_cvt_pk_bf16_f32 v242, v242, v243
  v_cvt_pk_bf16_f32 v244, v244, v245
  v_cvt_pk_bf16_f32 v246, v246, v247
  v_accvgpr_write_b32 a72, v240
  v_accvgpr_write_b32 a73, v242
  v_accvgpr_write_b32 a74, v244
  v_accvgpr_write_b32 a75, v246
  v_lshlrev_b32 v240, 16, v236
  v_and_b32 v241, s38, v236
  v_lshlrev_b32 v242, 16, v237
  v_and_b32 v243, s38, v237
  v_lshlrev_b32 v244, 16, v238
  v_and_b32 v245, s38, v238
  v_lshlrev_b32 v246, 16, v239
  v_and_b32 v247, s38, v239
  v_pk_mul_f32 v[240:241], v[240:241], s[36:37] op_sel_hi:[1,0]
  v_pk_mul_f32 v[242:243], v[242:243], s[36:37] op_sel_hi:[1,0]
  v_pk_mul_f32 v[244:245], v[244:245], s[36:37] op_sel_hi:[1,0]
  v_pk_mul_f32 v[246:247], v[246:247], s[36:37] op_sel_hi:[1,0]
  v_cvt_pk_bf16_f32 v240, v240, v241
  v_cvt_pk_bf16_f32 v242, v242, v243
  v_cvt_pk_bf16_f32 v244, v244, v245
  v_cvt_pk_bf16_f32 v246, v246, v247
  v_accvgpr_write_b32 a76, v240
  v_accvgpr_write_b32 a77, v242
  v_accvgpr_write_b32 a78, v244
  v_accvgpr_write_b32 a79, v246
  s_nop 1
  v_mfma_f32_16x16x32_bf16 v[36:39], a[96:99], a[64:67], 0
  v_mfma_f32_16x16x32_bf16 v[36:39], a[100:103], a[68:71], v[36:39]
  v_mfma_f32_16x16x32_bf16 v[36:39], a[104:107], a[72:75], v[36:39]
  v_mfma_f32_16x16x32_bf16 v[36:39], a[108:111], a[76:79], v[36:39]
  v_mfma_f32_16x16x32_bf16 v[32:35], a[112:115], a[64:67], 0
  v_mfma_f32_16x16x32_bf16 v[32:35], a[116:119], a[68:71], v[32:35]
  v_mfma_f32_16x16x32_bf16 v[32:35], a[120:123], a[72:75], v[32:35]
  v_mfma_f32_16x16x32_bf16 v[32:35], a[124:127], a[76:79], v[32:35]
  s_nop 7
  v_max3_f32 v8, v36, v37, v38
  v_max3_f32 v8, v39, v32, v8
  v_max3_f32 v8, v33, v34, v8
  v_max_f32 v8, v35, v8
  v_mov_b32 v9, v8
  s_nop 1
  v_permlane16_swap_b32 v8, v9
  v_max_f32 v8, v8, v9
  v_mov_b32 v9, v8
  s_nop 1
  buffer_load_dwordx4 v2, s[20:23], s35 offen offset:1024 nt lds
  v_permlane32_swap_b32 v8, v9
  v_max_f32 v8, v8, v9
  v_sub_f32 v26, 0, v8
  v_add_f32 v36, v36, v26
  v_add_f32 v37, v37, v26
  v_add_f32 v38, v38, v26
  v_add_f32 v39, v39, v26
  v_add_f32 v32, v32, v26
  v_add_f32 v33, v33, v26
  v_add_f32 v34, v34, v26
  v_add_f32 v35, v35, v26
  v_exp_f32 v36, v36
  v_exp_f32 v37, v37
  v_exp_f32 v38, v38
  v_exp_f32 v39, v39
  v_exp_f32 v32, v32
  v_exp_f32 v33, v33
  v_exp_f32 v34, v34
  v_exp_f32 v35, v35
  v_mov_b32 v27, v26
  v_mov_b32 v28, v26
  v_mov_b32 v29, v26
  v_cvt_pk_bf16_f32 v36, v36, v37
  v_cvt_pk_bf16_f32 v37, v38, v39
  v_cvt_pk_bf16_f32 v38, v32, v33
  v_cvt_pk_bf16_f32 v39, v34, v35
  s_waitcnt vmcnt(3)
  buffer_load_dwordx4 v0, s[24:27], s35 offen offset:2048 nt lds
  s_waitcnt vmcnt(3)
  ds_read_b128 a[80:83], v3 offset:16384
  ds_read_b128 a[84:87], v3 offset:16640
  ds_read_b128 a[88:91], v3 offset:16896
  ds_read_b128 a[92:95], v3 offset:17152
  v_mfma_f32_16x16x32_bf16 v[192:195], a[128:131], v[36:39], 0
  v_mfma_f32_16x16x32_bf16 v[196:199], a[132:135], v[36:39], 0
  v_mfma_f32_16x16x32_bf16 v[200:203], a[136:139], v[36:39], 0
  v_mfma_f32_16x16x32_bf16 v[204:207], a[140:143], v[36:39], 0
  v_mfma_f32_16x16x32_bf16 v[208:211], a[144:147], v[36:39], 0
  v_mfma_f32_16x16x32_bf16 v[212:215], a[148:151], v[36:39], 0
  v_mfma_f32_16x16x32_bf16 v[216:219], a[152:155], v[36:39], 0
  v_mfma_f32_16x16x32_bf16 v[220:223], a[156:159], v[36:39], 0
  s_waitcnt lgkmcnt(0)
  s_nop 1
  v_mfma_f32_16x16x32_bf16 v[40:43], a[96:99], a[80:83], 0
  v_mfma_f32_16x16x32_bf16 v[40:43], a[100:103], a[84:87], v[40:43]
  v_mfma_f32_16x16x32_bf16 v[40:43], a[104:107], a[88:91], v[40:43]
  v_mfma_f32_16x16x32_bf16 v[40:43], a[108:111], a[92:95], v[40:43]
  v_mfma_f32_16x16x32_bf16 v[44:47], a[112:115], a[80:83], 0
  v_mfma_f32_16x16x32_bf16 v[44:47], a[116:119], a[84:87], v[44:47]
  v_mfma_f32_16x16x32_bf16 v[44:47], a[120:123], a[88:91], v[44:47]
  v_mfma_f32_16x16x32_bf16 v[44:47], a[124:127], a[92:95], v[44:47]
  s_nop 7
  v_max3_f32 v8, v40, v41, v42
  v_max3_f32 v8, v43, v44, v8
  v_max3_f32 v8, v45, v46, v8
  v_max_f32 v8, v47, v8
  v_mov_b32 v9, v8
  s_nop 1
  v_permlane16_swap_b32 v8, v9
  v_max_f32 v8, v8, v9
  buffer_load_dwordx4 v1, s[24:27], s35 offen offset:3072 nt lds
  v_mov_b32 v9, v8
  s_nop 1
  v_permlane32_swap_b32 v8, v9
  v_max_f32 v8, v8, v9
  v_mul_f32 v30, s36, -v8
  v_fma_f32 v40, v40, s36, v30
  v_fma_f32 v41, v41, s36, v30
  v_fma_f32 v42, v42, s36, v30
  v_fma_f32 v43, v43, s36, v30
  v_fma_f32 v44, v44, s36, v30
  v_fma_f32 v45, v45, s36, v30
  v_fma_f32 v46, v46, s36, v30
  v_fma_f32 v47, v47, s36, v30
  v_exp_f32 v40, v40
  v_exp_f32 v41, v41
  v_exp_f32 v42, v42
  v_exp_f32 v43, v43
  v_exp_f32 v44, v44
  v_exp_f32 v45, v45
  v_exp_f32 v46, v46
  v_exp_f32 v47, v47
  v_cvt_pk_bf16_f32 v40, v40, v41
  v_cvt_pk_bf16_f32 v41, v42, v43
  v_cvt_pk_bf16_f32 v42, v44, v45
  v_cvt_pk_bf16_f32 v43, v46, v47
L_join:
  s_add_u32 m0, s32, 32768
  s_xor_b32 s35, s33, 16384
  buffer_load_dwordx4 v2, s[20:23], s35 offen nt lds
  s_waitcnt vmcnt(3)
  s_barrier
  ds_read_b128 a[96:99], v4 offset:16384
  ds_read_b128 a[100:103], v4 offset:16640
  ds_read_b128 a[104:107], v4 offset:16896
  ds_read_b128 a[108:111], v4 offset:17152
  ds_read_b128 a[112:115], v4 offset:24576
  ds_read_b128 a[116:119], v4 offset:24832
  ds_read_b128 a[120:123], v4 offset:25088
  ds_read_b128 a[124:127], v4 offset:25344
  v_smfmac_f32_16x16x64_bf16 a[200:203], a[204:207], v[36:43], v7
  v_mfma_f32_16x16x32_bf16 v[224:227], a[128:131], v[40:43], 0
  v_mfma_f32_16x16x32_bf16 v[228:231], a[132:135], v[40:43], 0
  v_mfma_f32_16x16x32_bf16 v[232:235], a[136:139], v[40:43], 0
  v_mfma_f32_16x16x32_bf16 v[236:239], a[140:143], v[40:43], 0
  v_mfma_f32_16x16x32_bf16 v[240:243], a[144:147], v[40:43], 0
  v_mfma_f32_16x16x32_bf16 v[244:247], a[148:151], v[40:43], 0
  v_mfma_f32_16x16x32_bf16 v[248:251], a[152:155], v[40:43], 0
  v_mfma_f32_16x16x32_bf16 v[252:255], a[156:159], v[40:43], 0
  s_waitcnt lgkmcnt(7)
  v_mfma_f32_16x16x32_bf16 v[52:55], a[96:99], a[0:3], v[10:13]
  s_waitcnt lgkmcnt(0)
  v_mfma_f32_16x16x32_bf16 v[52:55], a[100:103], a[4:7], v[52:55]
  v_mfma_f32_16x16x32_bf16 v[52:55], a[104:107], a[8:11], v[52:55]
  buffer_load_dwordx4 v2, s[20:23], s35 offen offset:1024 nt lds
  v_mfma_f32_16x16x32_bf16 v[52:55], a[108:111], a[12:15], v[52:55]
  v_mfma_f32_16x16x32_bf16 v[48:51], a[112:115], a[0:3], v[10:13]
  v_mfma_f32_16x16x32_bf16 v[48:51], a[116:119], a[4:7], v[48:51]
  v_exp_f32 v52, v52
  v_mfma_f32_16x16x32_bf16 v[48:51], a[120:123], a[8:11], v[48:51]
  v_exp_f32 v53, v53
  v_mfma_f32_16x16x32_bf16 v[48:51], a[124:127], a[12:15], v[48:51]
  v_cvt_pk_bf16_f32 v52, v52, v53
  v_mfma_f32_16x16x32_bf16 v[56:59], a[96:99], a[16:19], v[14:17]
  v_exp_f32 v54, v54
  v_mfma_f32_16x16x32_bf16 v[56:59], a[100:103], a[20:23], v[56:59]
  v_exp_f32 v55, v55
  v_mfma_f32_16x16x32_bf16 v[56:59], a[104:107], a[24:27], v[56:59]
  v_cvt_pk_bf16_f32 v53, v54, v55
  v_mfma_f32_16x16x32_bf16 v[56:59], a[108:111], a[28:31], v[56:59]
  v_exp_f32 v48, v48
  v_mfma_f32_16x16x32_bf16 v[60:63], a[112:115], a[16:19], v[14:17]
  v_exp_f32 v49, v49
  v_mfma_f32_16x16x32_bf16 v[60:63], a[116:119], a[20:23], v[60:63]
  s_waitcnt vmcnt(2)
  s_barrier
  v_mfma_f32_16x16x32_bf16 v[60:63], a[120:123], a[24:27], v[60:63]
  ds_read_b64_tr_b16 a[128:129], v5 offset:18432
  ds_read_b64_tr_b16 a[130:131], v5 offset:26624
  v_mfma_f32_16x16x32_bf16 v[60:63], a[124:127], a[28:31], v[60:63]
  ds_read_b64_tr_b16 a[132:133], v6 offset:18432
  v_cvt_pk_bf16_f32 v54, v48, v49
  v_mfma_f32_16x16x32_bf16 v[36:39], a[96:99], a[32:35], v[18:21]
  ds_read_b64_tr_b16 a[134:135], v6 offset:26624
  ds_read_b64_tr_b16 a[136:137], v5 offset:18688
  v_mfma_f32_16x16x32_bf16 v[36:39], a[100:103], a[36:39], v[36:39]
  ds_read_b64_tr_b16 a[138:139], v5 offset:26880
  v_mfma_f32_16x16x32_bf16 v[36:39], a[104:107], a[40:43], v[36:39]
  ds_read_b64_tr_b16 a[140:141], v6 offset:18688
  ds_read_b64_tr_b16 a[142:143], v6 offset:26880
  v_mfma_f32_16x16x32_bf16 v[36:39], a[108:111], a[44:47], v[36:39]
  ds_read_b64_tr_b16 a[144:145], v5 offset:18944
  v_mfma_f32_16x16x32_bf16 v[32:35], a[112:115], a[32:35], v[18:21]
  ds_read_b64_tr_b16 a[146:147], v5 offset:27136
  ds_read_b64_tr_b16 a[148:149], v6 offset:18944
  v_mfma_f32_16x16x32_bf16 v[32:35], a[116:119], a[36:39], v[32:35]
  v_exp_f32 v56, v56
  v_mfma_f32_16x16x32_bf16 v[32:35], a[120:123], a[40:43], v[32:35]
  ds_read_b64_tr_b16 a[150:151], v6 offset:27136
  ds_read_b64_tr_b16 a[152:153], v5 offset:19200
  v_mfma_f32_16x16x32_bf16 v[32:35], a[124:127], a[44:47], v[32:35]
  v_exp_f32 v57, v57
  v_mfma_f32_16x16x32_bf16 v[40:43], a[96:99], a[48:51], v[22:25]
  ds_read_b64_tr_b16 a[154:155], v5 offset:27392
  v_cvt_pk_bf16_f32 v56, v56, v57
  v_mfma_f32_16x16x32_bf16 v[40:43], a[100:103], a[52:55], v[40:43]
  ds_read_b64_tr_b16 a[156:157], v6 offset:19200
  ds_read_b64_tr_b16 a[158:159], v6 offset:27392
  v_mfma_f32_16x16x32_bf16 v[40:43], a[104:107], a[56:59], v[40:43]
  v_exp_f32 v58, v58
  v_mfma_f32_16x16x32_bf16 v[40:43], a[108:111], a[60:63], v[40:43]
  v_exp_f32 v50, v50
  v_mfma_f32_16x16x32_bf16 v[44:47], a[112:115], a[48:51], v[22:25]
  v_exp_f32 v59, v59
  v_mfma_f32_16x16x32_bf16 v[44:47], a[116:119], a[52:55], v[44:47]
  v_exp_f32 v51, v51
  v_mfma_f32_16x16x32_bf16 v[44:47], a[120:123], a[56:59], v[44:47]
  v_cvt_pk_bf16_f32 v57, v58, v59
  v_cvt_pk_bf16_f32 v55, v50, v51
  v_mfma_f32_16x16x32_bf16 v[44:47], a[124:127], a[60:63], v[44:47]
  s_waitcnt lgkmcnt(5)
  buffer_load_dwordx4 v0, s[24:27], s35 offen offset:2048 nt lds
  v_mfma_f32_16x16x32_bf16 v[64:67], a[128:131], v[52:55], v[64:67]
  v_exp_f32 v60, v60
  v_mfma_f32_16x16x32_bf16 v[68:71], a[132:135], v[52:55], v[68:71]
  v_exp_f32 v61, v61
  v_mfma_f32_16x16x32_bf16 v[72:75], a[136:139], v[52:55], v[72:75]
  v_cvt_pk_bf16_f32 v58, v60, v61
  v_mfma_f32_16x16x32_bf16 v[76:79], a[140:143], v[52:55], v[76:79]
  v_exp_f32 v62, v62
  v_mfma_f32_16x16x32_bf16 v[80:83], a[144:147], v[52:55], v[80:83]
  s_waitcnt lgkmcnt(0)
  v_exp_f32 v63, v63
  v_mfma_f32_16x16x32_bf16 v[84:87], a[148:151], v[52:55], v[84:87]
  v_cvt_pk_bf16_f32 v59, v62, v63
  v_mfma_f32_16x16x32_bf16 v[88:91], a[152:155], v[52:55], v[88:91]
  v_exp_f32 v36, v36
  v_mfma_f32_16x16x32_bf16 v[92:95], a[156:159], v[52:55], v[92:95]
  v_exp_f32 v37, v37
  v_smfmac_f32_16x16x64_bf16 a[192:195], a[204:207], v[52:59], v7
  v_cvt_pk_bf16_f32 v36, v36, v37
  v_mfma_f32_16x16x32_bf16 v[96:99], a[128:131], v[56:59], v[96:99]
  buffer_load_dwordx4 v1, s[24:27], s35 offen offset:3072 nt lds
  v_mfma_f32_16x16x32_bf16 v[100:103], a[132:135], v[56:59], v[100:103]
  v_exp_f32 v38, v38
  v_mfma_f32_16x16x32_bf16 v[104:107], a[136:139], v[56:59], v[104:107]
  v_exp_f32 v39, v39
  v_mfma_f32_16x16x32_bf16 v[108:111], a[140:143], v[56:59], v[108:111]
  v_cvt_pk_bf16_f32 v37, v38, v39
  v_mfma_f32_16x16x32_bf16 v[112:115], a[144:147], v[56:59], v[112:115]
  v_exp_f32 v40, v40
  v_mfma_f32_16x16x32_bf16 v[116:119], a[148:151], v[56:59], v[116:119]
  v_exp_f32 v32, v32
  v_mfma_f32_16x16x32_bf16 v[120:123], a[152:155], v[56:59], v[120:123]
  v_exp_f32 v41, v41
  v_mfma_f32_16x16x32_bf16 v[124:127], a[156:159], v[56:59], v[124:127]
  v_exp_f32 v33, v33
  v_mfma_f32_16x16x32_bf16 v[52:55], a[96:99], a[64:67], v[26:29]
  v_cvt_pk_bf16_f32 v40, v40, v41
  v_cvt_pk_bf16_f32 v38, v32, v33
  v_mfma_f32_16x16x32_bf16 v[52:55], a[100:103], a[68:71], v[52:55]
  v_exp_f32 v42, v42
  v_mfma_f32_16x16x32_bf16 v[52:55], a[104:107], a[72:75], v[52:55]
  v_exp_f32 v34, v34
  v_mfma_f32_16x16x32_bf16 v[52:55], a[108:111], a[76:79], v[52:55]
  v_exp_f32 v43, v43
  v_mfma_f32_16x16x32_bf16 v[48:51], a[112:115], a[64:67], v[26:29]
  v_exp_f32 v35, v35
  v_mfma_f32_16x16x32_bf16 v[48:51], a[116:119], a[68:71], v[48:51]
  v_cvt_pk_bf16_f32 v41, v42, v43
  v_cvt_pk_bf16_f32 v39, v34, v35
  v_mfma_f32_16x16x32_bf16 v[48:51], a[120:123], a[72:75], v[48:51]
  v_exp_f32 v44, v44
  v_mfma_f32_16x16x32_bf16 v[48:51], a[124:127], a[76:79], v[48:51]
  s_waitcnt vmcnt(2)
  s_barrier
  v_mfma_f32_16x16x32_bf16 v[56:59], a[96:99], a[80:83], 0
  v_exp_f32 v45, v45
  v_mfma_f32_16x16x32_bf16 v[56:59], a[100:103], a[84:87], v[56:59]
  ds_read_b128 a[96:99], v4 offset:32768
  v_cvt_pk_bf16_f32 v42, v44, v45
  v_mfma_f32_16x16x32_bf16 v[56:59], a[104:107], a[88:91], v[56:59]
  v_exp_f32 v46, v46
  v_mfma_f32_16x16x32_bf16 v[56:59], a[108:111], a[92:95], v[56:59]
  v_exp_f32 v47, v47
  v_mfma_f32_16x16x32_bf16 v[60:63], a[112:115], a[80:83], 0
  ds_read_b128 a[100:103], v4 offset:33024
  v_cvt_pk_bf16_f32 v43, v46, v47
  v_mfma_f32_16x16x32_bf16 v[60:63], a[116:119], a[84:87], v[60:63]
L_isl2:
  s_cbranch_execz L_retA
  v_exp_f32 v52, v52
  v_mfma_f32_16x16x32_bf16 v[60:63], a[120:123], a[88:91], v[60:63]
  ds_read_b128 a[104:107], v4 offset:33280
  v_fma_f32 v56, v56, s36, v30
  v_mfma_f32_16x16x32_bf16 v[60:63], a[124:127], a[92:95], v[60:63]
  v_exp_f32 v53, v53
  v_mfma_f32_16x16x32_bf16 v[128:131], a[128:131], v[36:39], v[128:131]
  ds_read_b128 a[108:111], v4 offset:33536
  v_cvt_pk_bf16_f32 v52, v52, v53
  v_mfma_f32_16x16x32_bf16 v[132:135], a[132:135], v[36:39], v[132:135]
  v_exp_f32 v54, v54
  v_mfma_f32_16x16x32_bf16 v[136:139], a[136:139], v[36:39], v[136:139]
  ds_read_b128 a[112:115], v4 offset:40960
  v_fma_f32 v57, v57, s36, v30
  v_mfma_f32_16x16x32_bf16 v[140:143], a[140:143], v[36:39], v[140:143]
  v_exp_f32 v55, v55
  v_mfma_f32_16x16x32_bf16 v[144:147], a[144:147], v[36:39], v[144:147]
  ds_read_b128 a[116:119], v4 offset:41216
  v_cvt_pk_bf16_f32 v53, v54, v55
  v_mfma_f32_16x16x32_bf16 v[148:151], a[148:151], v[36:39], v[148:151]
  v_exp_f32 v56, v56
  v_mfma_f32_16x16x32_bf16 v[152:155], a[152:155], v[36:39], v[152:155]
  ds_read_b128 a[120:123], v4 offset:41472
  v_fma_f32 v58, v58, s36, v30
  v_mfma_f32_16x16x32_bf16 v[156:159], a[156:159], v[36:39], v[156:159]
  s_add_u32 m0, s32, 49152
  v_exp_f32 v48, v48
  v_smfmac_f32_16x16x64_bf16 a[196:199], a[204:207], v[36:43], v7
  s_xor_b32 s35, s33, 24576
  ds_read_b128 a[124:127], v4 offset:41728
  v_mfma_f32_16x16x32_bf16 v[160:163], a[128:131], v[40:43], v[160:163]
  buffer_load_dwordx4 v2, s[20:23], s35 offen nt lds
  v_mfma_f32_16x16x32_bf16 v[164:167], a[132:135], v[40:43], v[164:167]
  v_exp_f32 v57, v57
  v_mfma_f32_16x16x32_bf16 v[168:171], a[136:139], v[40:43], v[168:171]
  v_exp_f32 v49, v49
  v_mfma_f32_16x16x32_bf16 v[172:175], a[140:143], v[40:43], v[172:175]
  v_cvt_pk_bf16_f32 v56, v56, v57
  v_cvt_pk_bf16_f32 v54, v48, v49
  v_mfma_f32_16x16x32_bf16 v[176:179], a[144:147], v[40:43], v[176:179]
  v_fma_f32 v59, v59, s36, v30
  v_fma_f32 v60, v60, s36, v30
  v_mfma_f32_16x16x32_bf16 v[180:183], a[148:151], v[40:43], v[180:183]
  v_exp_f32 v58, v58
  v_mfma_f32_16x16x32_bf16 v[184:187], a[152:155], v[40:43], v[184:187]
  v_exp_f32 v50, v50
  v_mfma_f32_16x16x32_bf16 v[188:191], a[156:159], v[40:43], v[188:191]
  s_waitcnt lgkmcnt(1)
  v_exp_f32 v59, v59
  v_mfma_f32_16x16x32_bf16 v[36:39], a[96:99], a[0:3], v[10:13]
  v_exp_f32 v51, v51
  v_mfma_f32_16x16x32_bf16 v[36:39], a[100:103], a[4:7], v[36:39]
  v_cvt_pk_bf16_f32 v57, v58, v59
  v_cvt_pk_bf16_f32 v55, v50, v51
  v_mfma_f32_16x16x32_bf16 v[36:39], a[104:107], a[8:11], v[36:39]
  v_fma_f32 v61, v61, s36, v30
  v_fma_f32 v62, v62, s36, v30
  v_mfma_f32_16x16x32_bf16 v[36:39], a[108:111], a[12:15], v[36:39]
  v_exp_f32 v60, v60
  v_mfma_f32_16x16x32_bf16 v[32:35], a[112:115], a[0:3], v[10:13]
  v_exp_f32 v61, v61
  v_mfma_f32_16x16x32_bf16 v[32:35], a[116:119], a[4:7], v[32:35]
  v_cvt_pk_bf16_f32 v58, v60, v61
  v_fma_f32 v63, v63, s36, v30
  v_mfma_f32_16x16x32_bf16 v[32:35], a[120:123], a[8:11], v[32:35]
  s_waitcnt lgkmcnt(0)
  v_exp_f32 v62, v62
  v_mfma_f32_16x16x32_bf16 v[32:35], a[124:127], a[12:15], v[32:35]
  v_exp_f32 v63, v63
  v_mfma_f32_16x16x32_bf16 v[40:43], a[96:99], a[16:19], v[14:17]
  buffer_load_dwordx4 v2, s[20:23], s35 offen offset:1024 nt lds
  v_mfma_f32_16x16x32_bf16 v[40:43], a[100:103], a[20:23], v[40:43]
  v_exp_f32 v36, v36
  v_mfma_f32_16x16x32_bf16 v[40:43], a[104:107], a[24:27], v[40:43]
  v_exp_f32 v37, v37
  v_mfma_f32_16x16x32_bf16 v[40:43], a[108:111], a[28:31], v[40:43]
  v_cvt_pk_bf16_f32 v59, v62, v63
  v_cvt_pk_bf16_f32 v36, v36, v37
  v_mfma_f32_16x16x32_bf16 v[44:47], a[112:115], a[16:19], v[14:17]
  v_exp_f32 v38, v38
  v_mfma_f32_16x16x32_bf16 v[44:47], a[116:119], a[20:23], v[44:47]
  v_exp_f32 v39, v39
  v_mfma_f32_16x16x32_bf16 v[44:47], a[120:123], a[24:27], v[44:47]
  v_cvt_pk_bf16_f32 v37, v38, v39
  v_mfma_f32_16x16x32_bf16 v[44:47], a[124:127], a[28:31], v[44:47]
  v_exp_f32 v40, v40
  v_mfma_f32_16x16x32_bf16 v[192:195], a[128:131], v[52:55], v[192:195]
  v_exp_f32 v32, v32
  v_mfma_f32_16x16x32_bf16 v[196:199], a[132:135], v[52:55], v[196:199]
  v_exp_f32 v41, v41
  v_mfma_f32_16x16x32_bf16 v[200:203], a[136:139], v[52:55], v[200:203]
  v_exp_f32 v33, v33
  v_mfma_f32_16x16x32_bf16 v[204:207], a[140:143], v[52:55], v[204:207]
  v_cvt_pk_bf16_f32 v40, v40, v41
  v_cvt_pk_bf16_f32 v38, v32, v33
  v_mfma_f32_16x16x32_bf16 v[208:211], a[144:147], v[52:55], v[208:211]
  v_exp_f32 v42, v42
  v_mfma_f32_16x16x32_bf16 v[212:215], a[148:151], v[52:55], v[212:215]
  v_exp_f32 v34, v34
  v_mfma_f32_16x16x32_bf16 v[216:219], a[152:155], v[52:55], v[216:219]
  v_exp_f32 v43, v43
  v_mfma_f32_16x16x32_bf16 v[220:223], a[156:159], v[52:55], v[220:223]
  v_exp_f32 v35, v35
  v_smfmac_f32_16x16x64_bf16 a[200:203], a[204:207], v[52:59], v7
  s_waitcnt vmcnt(2)
  s_barrier
  v_mfma_f32_16x16x32_bf16 v[224:227], a[128:131], v[56:59], v[224:227]
  ds_read_b64_tr_b16 a[128:129], v5 offset:34816
  ds_read_b64_tr_b16 a[130:131], v5 offset:43008
  v_mfma_f32_16x16x32_bf16 v[228:231], a[132:135], v[56:59], v[228:231]
  ds_read_b64_tr_b16 a[132:133], v6 offset:34816
  v_cvt_pk_bf16_f32 v41, v42, v43
  v_mfma_f32_16x16x32_bf16 v[232:235], a[136:139], v[56:59], v[232:235]
  ds_read_b64_tr_b16 a[134:135], v6 offset:43008
  ds_read_b64_tr_b16 a[136:137], v5 offset:35072
  v_mfma_f32_16x16x32_bf16 v[236:239], a[140:143], v[56:59], v[236:239]
  ds_read_b64_tr_b16 a[138:139], v5 offset:43264
  v_cvt_pk_bf16_f32 v39, v34, v35
  v_mfma_f32_16x16x32_bf16 v[240:243], a[144:147], v[56:59], v[240:243]
  ds_read_b64_tr_b16 a[140:141], v6 offset:35072
  ds_read_b64_tr_b16 a[142:143], v6 offset:43264
  v_mfma_f32_16x16x32_bf16 v[244:247], a[148:151], v[56:59], v[244:247]
  ds_read_b64_tr_b16 a[144:145], v5 offset:35328
  v_mfma_f32_16x16x32_bf16 v[248:251], a[152:155], v[56:59], v[248:251]
  ds_read_b64_tr_b16 a[146:147], v5 offset:43520
  ds_read_b64_tr_b16 a[148:149], v6 offset:35328
  v_mfma_f32_16x16x32_bf16 v[252:255], a[156:159], v[56:59], v[252:255]
  ds_read_b64_tr_b16 a[150:151], v6 offset:43520
  v_mfma_f32_16x16x32_bf16 v[52:55], a[96:99], a[32:35], v[18:21]
  ds_read_b64_tr_b16 a[152:153], v5 offset:35584
  ds_read_b64_tr_b16 a[154:155], v5 offset:43776
  v_mfma_f32_16x16x32_bf16 v[52:55], a[100:103], a[36:39], v[52:55]
  ds_read_b64_tr_b16 a[156:157], v6 offset:35584
  v_mfma_f32_16x16x32_bf16 v[52:55], a[104:107], a[40:43], v[52:55]
  v_exp_f32 v44, v44
  v_mfma_f32_16x16x32_bf16 v[52:55], a[108:111], a[44:47], v[52:55]
  v_exp_f32 v45, v45
  v_mfma_f32_16x16x32_bf16 v[48:51], a[112:115], a[32:35], v[18:21]
  ds_read_b64_tr_b16 a[158:159], v6 offset:43776
  v_cvt_pk_bf16_f32 v42, v44, v45
  v_mfma_f32_16x16x32_bf16 v[48:51], a[116:119], a[36:39], v[48:51]
  v_exp_f32 v46, v46
  v_mfma_f32_16x16x32_bf16 v[48:51], a[120:123], a[40:43], v[48:51]
  v_exp_f32 v47, v47
  v_mfma_f32_16x16x32_bf16 v[48:51], a[124:127], a[44:47], v[48:51]
  v_exp_f32 v52, v52
  v_mfma_f32_16x16x32_bf16 v[56:59], a[96:99], a[48:51], v[22:25]
  v_exp_f32 v53, v53
  v_mfma_f32_16x16x32_bf16 v[56:59], a[100:103], a[52:55], v[56:59]
  buffer_load_dwordx4 v0, s[24:27], s35 offen offset:2048 nt lds
  v_mfma_f32_16x16x32_bf16 v[56:59], a[104:107], a[56:59], v[56:59]
  v_cvt_pk_bf16_f32 v43, v46, v47
  v_cvt_pk_bf16_f32 v52, v52, v53
  v_mfma_f32_16x16x32_bf16 v[56:59], a[108:111], a[60:63], v[56:59]
  v_exp_f32 v54, v54
  v_mfma_f32_16x16x32_bf16 v[60:63], a[112:115], a[48:51], v[22:25]
  v_exp_f32 v55, v55
  v_mfma_f32_16x16x32_bf16 v[60:63], a[116:119], a[52:55], v[60:63]
  v_cvt_pk_bf16_f32 v53, v54, v55
  v_mfma_f32_16x16x32_bf16 v[60:63], a[120:123], a[56:59], v[60:63]
  v_exp_f32 v56, v56
  v_mfma_f32_16x16x32_bf16 v[60:63], a[124:127], a[60:63], v[60:63]
  s_waitcnt lgkmcnt(0)
  v_exp_f32 v48, v48
  v_mfma_f32_16x16x32_bf16 v[64:67], a[128:131], v[36:39], v[64:67]
  v_exp_f32 v57, v57
  v_mfma_f32_16x16x32_bf16 v[68:71], a[132:135], v[36:39], v[68:71]
  v_exp_f32 v49, v49
  v_mfma_f32_16x16x32_bf16 v[72:75], a[136:139], v[36:39], v[72:75]
  v_cvt_pk_bf16_f32 v56, v56, v57
  v_cvt_pk_bf16_f32 v54, v48, v49
  v_mfma_f32_16x16x32_bf16 v[76:79], a[140:143], v[36:39], v[76:79]
  v_exp_f32 v58, v58
  v_mfma_f32_16x16x32_bf16 v[80:83], a[144:147], v[36:39], v[80:83]
  v_exp_f32 v50, v50
  v_mfma_f32_16x16x32_bf16 v[84:87], a[148:151], v[36:39], v[84:87]
  v_exp_f32 v59, v59
  v_mfma_f32_16x16x32_bf16 v[88:91], a[152:155], v[36:39], v[88:91]
  v_exp_f32 v51, v51
  v_mfma_f32_16x16x32_bf16 v[92:95], a[156:159], v[36:39], v[92:95]
  v_cvt_pk_bf16_f32 v57, v58, v59
  v_cvt_pk_bf16_f32 v55, v50, v51
  v_smfmac_f32_16x16x64_bf16 a[192:195], a[204:207], v[36:43], v7
  v_mfma_f32_16x16x32_bf16 v[96:99], a[128:131], v[40:43], v[96:99]
  buffer_load_dwordx4 v1, s[24:27], s35 offen offset:3072 nt lds
  v_mfma_f32_16x16x32_bf16 v[100:103], a[132:135], v[40:43], v[100:103]
  v_exp_f32 v60, v60
  v_mfma_f32_16x16x32_bf16 v[104:107], a[136:139], v[40:43], v[104:107]
  v_exp_f32 v61, v61
  v_mfma_f32_16x16x32_bf16 v[108:111], a[140:143], v[40:43], v[108:111]
  v_exp_f32 v62, v62
  v_mfma_f32_16x16x32_bf16 v[112:115], a[144:147], v[40:43], v[112:115]
  v_exp_f32 v63, v63
  v_mfma_f32_16x16x32_bf16 v[116:119], a[148:151], v[40:43], v[116:119]
  v_cvt_pk_bf16_f32 v58, v60, v61
  v_cvt_pk_bf16_f32 v59, v62, v63
  v_mfma_f32_16x16x32_bf16 v[120:123], a[152:155], v[40:43], v[120:123]
  v_mfma_f32_16x16x32_bf16 v[124:127], a[156:159], v[40:43], v[124:127]
  v_mfma_f32_16x16x32_bf16 v[36:39], a[96:99], a[64:67], v[26:29]
  v_mfma_f32_16x16x32_bf16 v[36:39], a[100:103], a[68:71], v[36:39]
  v_mfma_f32_16x16x32_bf16 v[36:39], a[104:107], a[72:75], v[36:39]
  v_mfma_f32_16x16x32_bf16 v[36:39], a[108:111], a[76:79], v[36:39]
  v_mfma_f32_16x16x32_bf16 v[32:35], a[112:115], a[64:67], v[26:29]
  v_mfma_f32_16x16x32_bf16 v[32:35], a[116:119], a[68:71], v[32:35]
  v_exp_f32 v36, v36
  v_mfma_f32_16x16x32_bf16 v[32:35], a[120:123], a[72:75], v[32:35]
  v_exp_f32 v37, v37
  v_mfma_f32_16x16x32_bf16 v[32:35], a[124:127], a[76:79], v[32:35]
  s_waitcnt vmcnt(2)
  s_barrier
  v_mfma_f32_16x16x32_bf16 v[40:43], a[96:99], a[80:83], 0
  ds_read_b128 a[96:99], v4 offset:49152
  v_cvt_pk_bf16_f32 v36, v36, v37
  v_mfma_f32_16x16x32_bf16 v[40:43], a[100:103], a[84:87], v[40:43]
  v_exp_f32 v38, v38
  v_mfma_f32_16x16x32_bf16 v[40:43], a[104:107], a[88:91], v[40:43]
  ds_read_b128 a[100:103], v4 offset:49408
  v_mfma_f32_16x16x32_bf16 v[40:43], a[108:111], a[92:95], v[40:43]
  v_exp_f32 v39, v39
  v_mfma_f32_16x16x32_bf16 v[44:47], a[112:115], a[80:83], 0
  ds_read_b128 a[104:107], v4 offset:49664
  v_cvt_pk_bf16_f32 v37, v38, v39
  v_mfma_f32_16x16x32_bf16 v[44:47], a[116:119], a[84:87], v[44:47]
  v_fma_f32 v40, v40, s36, v30
  v_fma_f32 v41, v41, s36, v30
  v_mfma_f32_16x16x32_bf16 v[44:47], a[120:123], a[88:91], v[44:47]
  ds_read_b128 a[108:111], v4 offset:49920
  v_fma_f32 v42, v42, s36, v30
  v_mfma_f32_16x16x32_bf16 v[44:47], a[124:127], a[92:95], v[44:47]
  v_exp_f32 v40, v40
  v_mfma_f32_16x16x32_bf16 v[128:131], a[128:131], v[52:55], v[128:131]
  ds_read_b128 a[112:115], v4 offset:57344
  v_fma_f32 v43, v43, s36, v30
  v_mfma_f32_16x16x32_bf16 v[132:135], a[132:135], v[52:55], v[132:135]
  v_exp_f32 v32, v32
  v_mfma_f32_16x16x32_bf16 v[136:139], a[136:139], v[52:55], v[136:139]
  ds_read_b128 a[116:119], v4 offset:57600
  v_fma_f32 v44, v44, s36, v30
  v_mfma_f32_16x16x32_bf16 v[140:143], a[140:143], v[52:55], v[140:143]
  v_exp_f32 v41, v41
  v_mfma_f32_16x16x32_bf16 v[144:147], a[144:147], v[52:55], v[144:147]
  ds_read_b128 a[120:123], v4 offset:57856
  v_cvt_pk_bf16_f32 v40, v40, v41
  v_mfma_f32_16x16x32_bf16 v[148:151], a[148:151], v[52:55], v[148:151]
  v_exp_f32 v33, v33
  v_mfma_f32_16x16x32_bf16 v[152:155], a[152:155], v[52:55], v[152:155]
  ds_read_b128 a[124:127], v4 offset:58112
  v_cvt_pk_bf16_f32 v38, v32, v33
  v_mfma_f32_16x16x32_bf16 v[156:159], a[156:159], v[52:55], v[156:159]
  s_add_u32 m0, s32, 65536
  v_exp_f32 v42, v42
  v_smfmac_f32_16x16x64_bf16 a[196:199], a[204:207], v[52:59], v7
  s_xor_b32 s35, s33, 32768
  v_fma_f32 v45, v45, s36, v30
  v_mfma_f32_16x16x32_bf16 v[160:163], a[128:131], v[56:59], v[160:163]
  buffer_load_dwordx4 v2, s[20:23], s35 offen nt lds
  v_mfma_f32_16x16x32_bf16 v[164:167], a[132:135], v[56:59], v[164:167]
  v_exp_f32 v34, v34
  v_mfma_f32_16x16x32_bf16 v[168:171], a[136:139], v[56:59], v[168:171]
  v_exp_f32 v43, v43
  v_mfma_f32_16x16x32_bf16 v[172:175], a[140:143], v[56:59], v[172:175]
  v_exp_f32 v35, v35
  v_mfma_f32_16x16x32_bf16 v[176:179], a[144:147], v[56:59], v[176:179]
  v_cvt_pk_bf16_f32 v41, v42, v43
  v_cvt_pk_bf16_f32 v39, v34, v35
  v_mfma_f32_16x16x32_bf16 v[180:183], a[148:151], v[56:59], v[180:183]
  v_exp_f32 v44, v44
  v_mfma_f32_16x16x32_bf16 v[184:187], a[152:155], v[56:59], v[184:187]
  v_exp_f32 v45, v45
  v_mfma_f32_16x16x32_bf16 v[188:191], a[156:159], v[56:59], v[188:191]
  s_waitcnt lgkmcnt(0)
  v_cvt_pk_bf16_f32 v42, v44, v45
  v_fma_f32 v46, v46, s36, v30
  v_mfma_f32_16x16x32_bf16 v[52:55], a[96:99], a[0:3], v[10:13]
  v_fma_f32 v47, v47, s36, v30
  v_add_u32 v4, 0x10000, v4
  v_mfma_f32_16x16x32_bf16 v[52:55], a[100:103], a[4:7], v[52:55]
  v_exp_f32 v46, v46
  v_mfma_f32_16x16x32_bf16 v[52:55], a[104:107], a[8:11], v[52:55]
  v_exp_f32 v47, v47
  v_mfma_f32_16x16x32_bf16 v[52:55], a[108:111], a[12:15], v[52:55]
  v_cvt_pk_bf16_f32 v43, v46, v47
  v_mfma_f32_16x16x32_bf16 v[48:51], a[112:115], a[0:3], v[10:13]
  v_mfma_f32_16x16x32_bf16 v[48:51], a[116:119], a[4:7], v[48:51]
  v_exp_f32 v52, v52
  v_mfma_f32_16x16x32_bf16 v[48:51], a[120:123], a[8:11], v[48:51]
  v_exp_f32 v53, v53
  v_mfma_f32_16x16x32_bf16 v[48:51], a[124:127], a[12:15], v[48:51]
  v_cvt_pk_bf16_f32 v52, v52, v53
  v_mfma_f32_16x16x32_bf16 v[56:59], a[96:99], a[16:19], v[14:17]
  buffer_load_dwordx4 v2, s[20:23], s35 offen offset:1024 nt lds
  v_mfma_f32_16x16x32_bf16 v[56:59], a[100:103], a[20:23], v[56:59]
  v_exp_f32 v54, v54
  v_mfma_f32_16x16x32_bf16 v[56:59], a[104:107], a[24:27], v[56:59]
  v_exp_f32 v55, v55
  v_mfma_f32_16x16x32_bf16 v[56:59], a[108:111], a[28:31], v[56:59]
  v_cvt_pk_bf16_f32 v53, v54, v55
  v_mfma_f32_16x16x32_bf16 v[60:63], a[112:115], a[16:19], v[14:17]
  v_exp_f32 v48, v48
  v_mfma_f32_16x16x32_bf16 v[60:63], a[116:119], a[20:23], v[60:63]
  v_exp_f32 v56, v56
  v_mfma_f32_16x16x32_bf16 v[60:63], a[120:123], a[24:27], v[60:63]
  v_exp_f32 v57, v57
  v_mfma_f32_16x16x32_bf16 v[60:63], a[124:127], a[28:31], v[60:63]
  v_exp_f32 v49, v49
  v_mfma_f32_16x16x32_bf16 v[192:195], a[128:131], v[36:39], v[192:195]
  v_cvt_pk_bf16_f32 v56, v56, v57
  v_cvt_pk_bf16_f32 v54, v48, v49
  v_mfma_f32_16x16x32_bf16 v[196:199], a[132:135], v[36:39], v[196:199]
  v_exp_f32 v58, v58
  v_mfma_f32_16x16x32_bf16 v[200:203], a[136:139], v[36:39], v[200:203]
  v_exp_f32 v50, v50
  v_mfma_f32_16x16x32_bf16 v[204:207], a[140:143], v[36:39], v[204:207]
  v_exp_f32 v59, v59
  v_mfma_f32_16x16x32_bf16 v[208:211], a[144:147], v[36:39], v[208:211]
  v_exp_f32 v51, v51
  v_mfma_f32_16x16x32_bf16 v[212:215], a[148:151], v[36:39], v[212:215]
  v_cvt_pk_bf16_f32 v57, v58, v59
  v_cvt_pk_bf16_f32 v55, v50, v51
  v_mfma_f32_16x16x32_bf16 v[216:219], a[152:155], v[36:39], v[216:219]
  v_exp_f32 v60, v60
  v_mfma_f32_16x16x32_bf16 v[220:223], a[156:159], v[36:39], v[220:223]
  v_exp_f32 v61, v61
  v_smfmac_f32_16x16x64_bf16 a[200:203], a[204:207], v[36:43], v7
  s_waitcnt vmcnt(2)
  s_barrier
  v_mfma_f32_16x16x32_bf16 v[224:227], a[128:131], v[40:43], v[224:227]
  ds_read_b64_tr_b16 a[128:129], v5 offset:51200
  ds_read_b64_tr_b16 a[130:131], v5 offset:59392
  v_mfma_f32_16x16x32_bf16 v[228:231], a[132:135], v[40:43], v[228:231]
  ds_read_b64_tr_b16 a[132:133], v6 offset:51200
  v_cvt_pk_bf16_f32 v58, v60, v61
  v_mfma_f32_16x16x32_bf16 v[232:235], a[136:139], v[40:43], v[232:235]
  ds_read_b64_tr_b16 a[134:135], v6 offset:59392
  ds_read_b64_tr_b16 a[136:137], v5 offset:51456
  v_mfma_f32_16x16x32_bf16 v[236:239], a[140:143], v[40:43], v[236:239]
  ds_read_b64_tr_b16 a[138:139], v5 offset:59648
  v_mfma_f32_16x16x32_bf16 v[240:243], a[144:147], v[40:43], v[240:243]
  ds_read_b64_tr_b16 a[140:141], v6 offset:51456
  ds_read_b64_tr_b16 a[142:143], v6 offset:59648
  v_mfma_f32_16x16x32_bf16 v[244:247], a[148:151], v[40:43], v[244:247]
  ds_read_b64_tr_b16 a[144:145], v5 offset:51712
  v_mfma_f32_16x16x32_bf16 v[248:251], a[152:155], v[40:43], v[248:251]
  ds_read_b64_tr_b16 a[146:147], v5 offset:59904
  ds_read_b64_tr_b16 a[148:149], v6 offset:51712
  v_mfma_f32_16x16x32_bf16 v[252:255], a[156:159], v[40:43], v[252:255]
  ds_read_b64_tr_b16 a[150:151], v6 offset:59904
  v_mfma_f32_16x16x32_bf16 v[36:39], a[96:99], a[32:35], v[18:21]
  ds_read_b64_tr_b16 a[152:153], v5 offset:51968
  ds_read_b64_tr_b16 a[154:155], v5 offset:60160
  v_mfma_f32_16x16x32_bf16 v[36:39], a[100:103], a[36:39], v[36:39]
  ds_read_b64_tr_b16 a[156:157], v6 offset:51968
  v_mfma_f32_16x16x32_bf16 v[36:39], a[104:107], a[40:43], v[36:39]
  buffer_load_dwordx4 v0, s[24:27], s35 offen offset:2048 nt lds
  v_mfma_f32_16x16x32_bf16 v[36:39], a[108:111], a[44:47], v[36:39]
  ds_read_b64_tr_b16 a[158:159], v6 offset:60160
  v_add_u32 v5, 0x10000, v5
  v_mfma_f32_16x16x32_bf16 v[32:35], a[112:115], a[32:35], v[18:21]
  v_exp_f32 v62, v62
  v_mfma_f32_16x16x32_bf16 v[32:35], a[116:119], a[36:39], v[32:35]
  v_exp_f32 v63, v63
  v_mfma_f32_16x16x32_bf16 v[32:35], a[120:123], a[40:43], v[32:35]
  v_cvt_pk_bf16_f32 v59, v62, v63
  v_add_u32 v6, 0x10000, v6
  v_mfma_f32_16x16x32_bf16 v[32:35], a[124:127], a[44:47], v[32:35]
  v_exp_f32 v36, v36
  v_mfma_f32_16x16x32_bf16 v[40:43], a[96:99], a[48:51], v[22:25]
  v_exp_f32 v37, v37
  v_mfma_f32_16x16x32_bf16 v[40:43], a[100:103], a[52:55], v[40:43]
  v_cvt_pk_bf16_f32 v36, v36, v37
  v_mfma_f32_16x16x32_bf16 v[40:43], a[104:107], a[56:59], v[40:43]
  v_exp_f32 v38, v38
  v_mfma_f32_16x16x32_bf16 v[40:43], a[108:111], a[60:63], v[40:43]
  v_exp_f32 v39, v39
  v_mfma_f32_16x16x32_bf16 v[44:47], a[112:115], a[48:51], v[22:25]
  v_cvt_pk_bf16_f32 v37, v38, v39
  v_mfma_f32_16x16x32_bf16 v[44:47], a[116:119], a[52:55], v[44:47]
  v_exp_f32 v40, v40
  v_mfma_f32_16x16x32_bf16 v[44:47], a[120:123], a[56:59], v[44:47]
  v_exp_f32 v32, v32
  v_mfma_f32_16x16x32_bf16 v[44:47], a[124:127], a[60:63], v[44:47]
  s_waitcnt lgkmcnt(0)
  v_exp_f32 v41, v41
  v_mfma_f32_16x16x32_bf16 v[64:67], a[128:131], v[52:55], v[64:67]
  v_exp_f32 v33, v33
  v_mfma_f32_16x16x32_bf16 v[68:71], a[132:135], v[52:55], v[68:71]
  v_cvt_pk_bf16_f32 v40, v40, v41
  v_cvt_pk_bf16_f32 v38, v32, v33
  v_mfma_f32_16x16x32_bf16 v[72:75], a[136:139], v[52:55], v[72:75]
  buffer_load_dwordx4 v1, s[24:27], s35 offen offset:3072 nt lds
  v_mfma_f32_16x16x32_bf16 v[76:79], a[140:143], v[52:55], v[76:79]
  v_exp_f32 v42, v42
  v_mfma_f32_16x16x32_bf16 v[80:83], a[144:147], v[52:55], v[80:83]
  v_exp_f32 v34, v34
  v_mfma_f32_16x16x32_bf16 v[84:87], a[148:151], v[52:55], v[84:87]
  v_exp_f32 v43, v43
  v_mfma_f32_16x16x32_bf16 v[88:91], a[152:155], v[52:55], v[88:91]
  v_exp_f32 v35, v35
  v_mfma_f32_16x16x32_bf16 v[92:95], a[156:159], v[52:55], v[92:95]
  v_cvt_pk_bf16_f32 v41, v42, v43
  v_cvt_pk_bf16_f32 v39, v34, v35
  v_smfmac_f32_16x16x64_bf16 a[192:195], a[204:207], v[52:59], v7
  v_mfma_f32_16x16x32_bf16 v[96:99], a[128:131], v[56:59], v[96:99]
  v_exp_f32 v44, v44
  v_mfma_f32_16x16x32_bf16 v[100:103], a[132:135], v[56:59], v[100:103]
  v_exp_f32 v45, v45
  v_mfma_f32_16x16x32_bf16 v[104:107], a[136:139], v[56:59], v[104:107]
  v_exp_f32 v46, v46
  v_mfma_f32_16x16x32_bf16 v[108:111], a[140:143], v[56:59], v[108:111]
  v_exp_f32 v47, v47
  v_mfma_f32_16x16x32_bf16 v[112:115], a[144:147], v[56:59], v[112:115]
  v_cvt_pk_bf16_f32 v42, v44, v45
  v_cvt_pk_bf16_f32 v43, v46, v47
  v_mfma_f32_16x16x32_bf16 v[116:119], a[148:151], v[56:59], v[116:119]
  v_mfma_f32_16x16x32_bf16 v[120:123], a[152:155], v[56:59], v[120:123]
  v_mfma_f32_16x16x32_bf16 v[124:127], a[156:159], v[56:59], v[124:127]
  s_add_u32 m0, s32, 81920
  v_mfma_f32_16x16x32_bf16 v[52:55], a[96:99], a[64:67], v[26:29]
  s_xor_b32 s35, s33, 40960
  v_mfma_f32_16x16x32_bf16 v[52:55], a[100:103], a[68:71], v[52:55]
  buffer_load_dwordx4 v2, s[20:23], s35 offen nt lds
  v_mfma_f32_16x16x32_bf16 v[52:55], a[104:107], a[72:75], v[52:55]
  v_mfma_f32_16x16x32_bf16 v[52:55], a[108:111], a[76:79], v[52:55]
  v_mfma_f32_16x16x32_bf16 v[48:51], a[112:115], a[64:67], v[26:29]
  v_mfma_f32_16x16x32_bf16 v[48:51], a[116:119], a[68:71], v[48:51]
  v_exp_f32 v52, v52
  v_mfma_f32_16x16x32_bf16 v[48:51], a[120:123], a[72:75], v[48:51]
  v_exp_f32 v53, v53
  v_mfma_f32_16x16x32_bf16 v[48:51], a[124:127], a[76:79], v[48:51]
  s_waitcnt vmcnt(3)
  s_barrier
  v_mfma_f32_16x16x32_bf16 v[56:59], a[96:99], a[80:83], 0
  ds_read_b128 a[96:99], v4 offset:0
  v_cvt_pk_bf16_f32 v52, v52, v53
  v_mfma_f32_16x16x32_bf16 v[56:59], a[100:103], a[84:87], v[56:59]
  v_exp_f32 v54, v54
  v_mfma_f32_16x16x32_bf16 v[56:59], a[104:107], a[88:91], v[56:59]
  ds_read_b128 a[100:103], v4 offset:256
  v_mfma_f32_16x16x32_bf16 v[56:59], a[108:111], a[92:95], v[56:59]
  v_exp_f32 v55, v55
  v_mfma_f32_16x16x32_bf16 v[60:63], a[112:115], a[80:83], 0
  ds_read_b128 a[104:107], v4 offset:512
  v_cvt_pk_bf16_f32 v53, v54, v55
  v_mfma_f32_16x16x32_bf16 v[60:63], a[116:119], a[84:87], v[60:63]
  v_fma_f32 v56, v56, s36, v30
  v_fma_f32 v57, v57, s36, v30
  v_mfma_f32_16x16x32_bf16 v[60:63], a[120:123], a[88:91], v[60:63]
  ds_read_b128 a[108:111], v4 offset:768
  v_fma_f32 v58, v58, s36, v30
  v_mfma_f32_16x16x32_bf16 v[60:63], a[124:127], a[92:95], v[60:63]
  v_exp_f32 v56, v56
  v_mfma_f32_16x16x32_bf16 v[128:131], a[128:131], v[36:39], v[128:131]
  ds_read_b128 a[112:115], v4 offset:8192
  v_fma_f32 v59, v59, s36, v30
  v_mfma_f32_16x16x32_bf16 v[132:135], a[132:135], v[36:39], v[132:135]
  buffer_load_dwordx4 v2, s[20:23], s35 offen offset:1024 nt lds
  v_mfma_f32_16x16x32_bf16 v[136:139], a[136:139], v[36:39], v[136:139]
  ds_read_b128 a[116:119], v4 offset:8448
  v_fma_f32 v60, v60, s36, v30
  v_mfma_f32_16x16x32_bf16 v[140:143], a[140:143], v[36:39], v[140:143]
  v_exp_f32 v48, v48
  v_mfma_f32_16x16x32_bf16 v[144:147], a[144:147], v[36:39], v[144:147]
  ds_read_b128 a[120:123], v4 offset:8704
  v_fma_f32 v61, v61, s36, v30
  v_mfma_f32_16x16x32_bf16 v[148:151], a[148:151], v[36:39], v[148:151]
  v_exp_f32 v57, v57
  v_mfma_f32_16x16x32_bf16 v[152:155], a[152:155], v[36:39], v[152:155]
  ds_read_b128 a[124:127], v4 offset:8960
  v_cvt_pk_bf16_f32 v56, v56, v57
  v_mfma_f32_16x16x32_bf16 v[156:159], a[156:159], v[36:39], v[156:159]
  v_exp_f32 v49, v49
  v_smfmac_f32_16x16x64_bf16 a[196:199], a[204:207], v[36:43], v7
  v_cvt_pk_bf16_f32 v54, v48, v49
  v_mfma_f32_16x16x32_bf16 v[160:163], a[128:131], v[40:43], v[160:163]
  v_exp_f32 v58, v58
  v_mfma_f32_16x16x32_bf16 v[164:167], a[132:135], v[40:43], v[164:167]
  v_exp_f32 v50, v50
  v_mfma_f32_16x16x32_bf16 v[168:171], a[136:139], v[40:43], v[168:171]
  v_exp_f32 v59, v59
  v_mfma_f32_16x16x32_bf16 v[172:175], a[140:143], v[40:43], v[172:175]
  v_exp_f32 v51, v51
  v_mfma_f32_16x16x32_bf16 v[176:179], a[144:147], v[40:43], v[176:179]
  v_cvt_pk_bf16_f32 v57, v58, v59
  v_cvt_pk_bf16_f32 v55, v50, v51
  v_mfma_f32_16x16x32_bf16 v[180:183], a[148:151], v[40:43], v[180:183]
  v_exp_f32 v60, v60
  v_mfma_f32_16x16x32_bf16 v[184:187], a[152:155], v[40:43], v[184:187]
  v_exp_f32 v61, v61
  v_mfma_f32_16x16x32_bf16 v[188:191], a[156:159], v[40:43], v[188:191]
  s_waitcnt lgkmcnt(0)
  v_cvt_pk_bf16_f32 v58, v60, v61
  v_fma_f32 v62, v62, s36, v30
  v_mfma_f32_16x16x32_bf16 v[36:39], a[96:99], a[0:3], v[10:13]
  buffer_load_dwordx4 v0, s[24:27], s35 offen offset:2048 nt lds
  v_mfma_f32_16x16x32_bf16 v[36:39], a[100:103], a[4:7], v[36:39]
  v_exp_f32 v62, v62
  v_mfma_f32_16x16x32_bf16 v[36:39], a[104:107], a[8:11], v[36:39]
  v_fma_f32 v63, v63, s36, v30
  v_mfma_f32_16x16x32_bf16 v[36:39], a[108:111], a[12:15], v[36:39]
  v_exp_f32 v63, v63
  v_mfma_f32_16x16x32_bf16 v[32:35], a[112:115], a[0:3], v[10:13]
  v_cvt_pk_bf16_f32 v59, v62, v63
  v_mfma_f32_16x16x32_bf16 v[32:35], a[116:119], a[4:7], v[32:35]
  v_exp_f32 v36, v36
  v_mfma_f32_16x16x32_bf16 v[32:35], a[120:123], a[8:11], v[32:35]
  v_exp_f32 v37, v37
  v_mfma_f32_16x16x32_bf16 v[32:35], a[124:127], a[12:15], v[32:35]
  v_cvt_pk_bf16_f32 v36, v36, v37
  v_mfma_f32_16x16x32_bf16 v[40:43], a[96:99], a[16:19], v[14:17]
  v_exp_f32 v38, v38
  v_mfma_f32_16x16x32_bf16 v[40:43], a[100:103], a[20:23], v[40:43]
  v_exp_f32 v39, v39
  v_mfma_f32_16x16x32_bf16 v[40:43], a[104:107], a[24:27], v[40:43]
  v_cvt_pk_bf16_f32 v37, v38, v39
  v_mfma_f32_16x16x32_bf16 v[40:43], a[108:111], a[28:31], v[40:43]
  v_exp_f32 v32, v32
  v_mfma_f32_16x16x32_bf16 v[44:47], a[112:115], a[16:19], v[14:17]
  v_exp_f32 v33, v33
  v_mfma_f32_16x16x32_bf16 v[44:47], a[116:119], a[20:23], v[44:47]
  v_exp_f32 v40, v40
  v_mfma_f32_16x16x32_bf16 v[44:47], a[120:123], a[24:27], v[44:47]
  v_exp_f32 v41, v41
  v_mfma_f32_16x16x32_bf16 v[44:47], a[124:127], a[28:31], v[44:47]
  v_cvt_pk_bf16_f32 v40, v40, v41
  v_cvt_pk_bf16_f32 v38, v32, v33
  v_mfma_f32_16x16x32_bf16 v[192:195], a[128:131], v[52:55], v[192:195]
  buffer_load_dwordx4 v1, s[24:27], s35 offen offset:3072 nt lds
  v_mfma_f32_16x16x32_bf16 v[196:199], a[132:135], v[52:55], v[196:199]
  v_exp_f32 v42, v42
  v_mfma_f32_16x16x32_bf16 v[200:203], a[136:139], v[52:55], v[200:203]
  v_exp_f32 v34, v34
  v_mfma_f32_16x16x32_bf16 v[204:207], a[140:143], v[52:55], v[204:207]
  v_exp_f32 v43, v43
  v_mfma_f32_16x16x32_bf16 v[208:211], a[144:147], v[52:55], v[208:211]
  v_exp_f32 v35, v35
  v_mfma_f32_16x16x32_bf16 v[212:215], a[148:151], v[52:55], v[212:215]
  v_cvt_pk_bf16_f32 v41, v42, v43
  v_cvt_pk_bf16_f32 v39, v34, v35
  v_mfma_f32_16x16x32_bf16 v[216:219], a[152:155], v[52:55], v[216:219]
  v_exp_f32 v44, v44
  v_mfma_f32_16x16x32_bf16 v[220:223], a[156:159], v[52:55], v[220:223]
  v_exp_f32 v45, v45
  v_smfmac_f32_16x16x64_bf16 a[200:203], a[204:207], v[52:59], v7
  s_waitcnt vmcnt(4)
  s_barrier
  v_mfma_f32_16x16x32_bf16 v[224:227], a[128:131], v[56:59], v[224:227]
  ds_read_b64_tr_b16 a[128:129], v5 offset:2048
  ds_read_b64_tr_b16 a[130:131], v5 offset:10240
  v_mfma_f32_16x16x32_bf16 v[228:231], a[132:135], v[56:59], v[228:231]
  ds_read_b64_tr_b16 a[132:133], v6 offset:2048
  v_cvt_pk_bf16_f32 v42, v44, v45
  v_mfma_f32_16x16x32_bf16 v[232:235], a[136:139], v[56:59], v[232:235]
  ds_read_b64_tr_b16 a[134:135], v6 offset:10240
  ds_read_b64_tr_b16 a[136:137], v5 offset:2304
  v_mfma_f32_16x16x32_bf16 v[236:239], a[140:143], v[56:59], v[236:239]
  ds_read_b64_tr_b16 a[138:139], v5 offset:10496
  v_mfma_f32_16x16x32_bf16 v[240:243], a[144:147], v[56:59], v[240:243]
  ds_read_b64_tr_b16 a[140:141], v6 offset:2304
  ds_read_b64_tr_b16 a[142:143], v6 offset:10496
  v_mfma_f32_16x16x32_bf16 v[244:247], a[148:151], v[56:59], v[244:247]
  s_add_u32 m0, s32, 98304
  ds_read_b64_tr_b16 a[144:145], v5 offset:2560
  v_mfma_f32_16x16x32_bf16 v[248:251], a[152:155], v[56:59], v[248:251]
  s_xor_b32 s35, s33, 49152
  ds_read_b64_tr_b16 a[146:147], v5 offset:10752
  ds_read_b64_tr_b16 a[148:149], v6 offset:2560
  v_mfma_f32_16x16x32_bf16 v[252:255], a[156:159], v[56:59], v[252:255]
  buffer_load_dwordx4 v2, s[20:23], s35 offen nt lds
  v_mfma_f32_16x16x32_bf16 v[52:55], a[96:99], a[32:35], v[18:21]
  ds_read_b64_tr_b16 a[150:151], v6 offset:10752
  ds_read_b64_tr_b16 a[152:153], v5 offset:2816
  v_mfma_f32_16x16x32_bf16 v[52:55], a[100:103], a[36:39], v[52:55]
  ds_read_b64_tr_b16 a[154:155], v5 offset:11008
  v_mfma_f32_16x16x32_bf16 v[52:55], a[104:107], a[40:43], v[52:55]
  ds_read_b64_tr_b16 a[156:157], v6 offset:2816
  ds_read_b64_tr_b16 a[158:159], v6 offset:11008
  v_mfma_f32_16x16x32_bf16 v[52:55], a[108:111], a[44:47], v[52:55]
  v_exp_f32 v46, v46
  v_mfma_f32_16x16x32_bf16 v[48:51], a[112:115], a[32:35], v[18:21]
  v_exp_f32 v47, v47
  v_mfma_f32_16x16x32_bf16 v[48:51], a[116:119], a[36:39], v[48:51]
  v_exp_f32 v52, v52
  v_mfma_f32_16x16x32_bf16 v[48:51], a[120:123], a[40:43], v[48:51]
L_isl3:
  s_cbranch_execz L_retA
  v_exp_f32 v53, v53
  v_mfma_f32_16x16x32_bf16 v[48:51], a[124:127], a[44:47], v[48:51]
  v_cvt_pk_bf16_f32 v43, v46, v47
  v_cvt_pk_bf16_f32 v52, v52, v53
  v_mfma_f32_16x16x32_bf16 v[56:59], a[96:99], a[48:51], v[22:25]
  v_exp_f32 v54, v54
  v_mfma_f32_16x16x32_bf16 v[56:59], a[100:103], a[52:55], v[56:59]
  v_exp_f32 v55, v55
  v_mfma_f32_16x16x32_bf16 v[56:59], a[104:107], a[56:59], v[56:59]
  v_cvt_pk_bf16_f32 v53, v54, v55
  v_mfma_f32_16x16x32_bf16 v[56:59], a[108:111], a[60:63], v[56:59]
  v_exp_f32 v48, v48
  v_mfma_f32_16x16x32_bf16 v[60:63], a[112:115], a[48:51], v[22:25]
  v_exp_f32 v49, v49
  v_mfma_f32_16x16x32_bf16 v[60:63], a[116:119], a[52:55], v[60:63]
  v_exp_f32 v56, v56
  v_mfma_f32_16x16x32_bf16 v[60:63], a[120:123], a[56:59], v[60:63]
  v_exp_f32 v57, v57
  v_mfma_f32_16x16x32_bf16 v[60:63], a[124:127], a[60:63], v[60:63]
  s_waitcnt lgkmcnt(0)
  buffer_load_dwordx4 v2, s[20:23], s35 offen offset:1024 nt lds
  v_mfma_f32_16x16x32_bf16 v[64:67], a[128:131], v[36:39], v[64:67]
  v_cvt_pk_bf16_f32 v56, v56, v57
  v_cvt_pk_bf16_f32 v54, v48, v49
  v_mfma_f32_16x16x32_bf16 v[68:71], a[132:135], v[36:39], v[68:71]
  v_exp_f32 v58, v58
  v_mfma_f32_16x16x32_bf16 v[72:75], a[136:139], v[36:39], v[72:75]
  v_exp_f32 v50, v50
  v_mfma_f32_16x16x32_bf16 v[76:79], a[140:143], v[36:39], v[76:79]
  v_exp_f32 v59, v59
  v_mfma_f32_16x16x32_bf16 v[80:83], a[144:147], v[36:39], v[80:83]
  v_exp_f32 v51, v51
  v_mfma_f32_16x16x32_bf16 v[84:87], a[148:151], v[36:39], v[84:87]
  v_cvt_pk_bf16_f32 v57, v58, v59
  v_cvt_pk_bf16_f32 v55, v50, v51
  v_mfma_f32_16x16x32_bf16 v[88:91], a[152:155], v[36:39], v[88:91]
  v_exp_f32 v60, v60
  v_mfma_f32_16x16x32_bf16 v[92:95], a[156:159], v[36:39], v[92:95]
  v_exp_f32 v61, v61
  v_smfmac_f32_16x16x64_bf16 a[192:195], a[204:207], v[36:43], v7
  v_cvt_pk_bf16_f32 v58, v60, v61
  v_mfma_f32_16x16x32_bf16 v[96:99], a[128:131], v[40:43], v[96:99]
  v_exp_f32 v62, v62
  v_mfma_f32_16x16x32_bf16 v[100:103], a[132:135], v[40:43], v[100:103]
  v_exp_f32 v63, v63
  v_mfma_f32_16x16x32_bf16 v[104:107], a[136:139], v[40:43], v[104:107]
  v_cvt_pk_bf16_f32 v59, v62, v63
  v_mfma_f32_16x16x32_bf16 v[108:111], a[140:143], v[40:43], v[108:111]
  v_mfma_f32_16x16x32_bf16 v[112:115], a[144:147], v[40:43], v[112:115]
  v_mfma_f32_16x16x32_bf16 v[116:119], a[148:151], v[40:43], v[116:119]
  v_mfma_f32_16x16x32_bf16 v[120:123], a[152:155], v[40:43], v[120:123]
  buffer_load_dwordx4 v0, s[24:27], s35 offen offset:2048 nt lds
  v_mfma_f32_16x16x32_bf16 v[124:127], a[156:159], v[40:43], v[124:127]
  v_mfma_f32_16x16x32_bf16 v[36:39], a[96:99], a[64:67], v[26:29]
  v_mfma_f32_16x16x32_bf16 v[36:39], a[100:103], a[68:71], v[36:39]
  v_mfma_f32_16x16x32_bf16 v[36:39], a[104:107], a[72:75], v[36:39]
  v_mfma_f32_16x16x32_bf16 v[36:39], a[108:111], a[76:79], v[36:39]
  v_mfma_f32_16x16x32_bf16 v[32:35], a[112:115], a[64:67], v[26:29]
  v_mfma_f32_16x16x32_bf16 v[32:35], a[116:119], a[68:71], v[32:35]
  v_exp_f32 v36, v36
  v_mfma_f32_16x16x32_bf16 v[32:35], a[120:123], a[72:75], v[32:35]
  v_exp_f32 v37, v37
  v_mfma_f32_16x16x32_bf16 v[32:35], a[124:127], a[76:79], v[32:35]
  s_waitcnt vmcnt(5)
  s_barrier
  v_mfma_f32_16x16x32_bf16 v[40:43], a[96:99], a[80:83], 0
  ds_read_b128 a[96:99], v4 offset:16384
  v_cvt_pk_bf16_f32 v36, v36, v37
  v_mfma_f32_16x16x32_bf16 v[40:43], a[100:103], a[84:87], v[40:43]
  v_exp_f32 v38, v38
  v_mfma_f32_16x16x32_bf16 v[40:43], a[104:107], a[88:91], v[40:43]
  ds_read_b128 a[100:103], v4 offset:16640
  v_mfma_f32_16x16x32_bf16 v[40:43], a[108:111], a[92:95], v[40:43]
  v_exp_f32 v39, v39
  v_mfma_f32_16x16x32_bf16 v[44:47], a[112:115], a[80:83], 0
  ds_read_b128 a[104:107], v4 offset:16896
  v_cvt_pk_bf16_f32 v37, v38, v39
  v_mfma_f32_16x16x32_bf16 v[44:47], a[116:119], a[84:87], v[44:47]
  v_fma_f32 v40, v40, s36, v30
  v_fma_f32 v41, v41, s36, v30
  v_mfma_f32_16x16x32_bf16 v[44:47], a[120:123], a[88:91], v[44:47]
  buffer_load_dwordx4 v1, s[24:27], s35 offen offset:3072 nt lds
  v_mfma_f32_16x16x32_bf16 v[44:47], a[124:127], a[92:95], v[44:47]
  ds_read_b128 a[108:111], v4 offset:17152
  v_fma_f32 v42, v42, s36, v30
  v_mfma_f32_16x16x32_bf16 v[128:131], a[128:131], v[52:55], v[128:131]
  v_exp_f32 v40, v40
  v_mfma_f32_16x16x32_bf16 v[132:135], a[132:135], v[52:55], v[132:135]
  ds_read_b128 a[112:115], v4 offset:24576
  v_fma_f32 v43, v43, s36, v30
  v_mfma_f32_16x16x32_bf16 v[136:139], a[136:139], v[52:55], v[136:139]
  v_exp_f32 v32, v32
  v_mfma_f32_16x16x32_bf16 v[140:143], a[140:143], v[52:55], v[140:143]
  ds_read_b128 a[116:119], v4 offset:24832
  v_fma_f32 v44, v44, s36, v30
  v_mfma_f32_16x16x32_bf16 v[144:147], a[144:147], v[52:55], v[144:147]
  v_exp_f32 v41, v41
  v_mfma_f32_16x16x32_bf16 v[148:151], a[148:151], v[52:55], v[148:151]
  ds_read_b128 a[120:123], v4 offset:25088
  v_cvt_pk_bf16_f32 v40, v40, v41
  v_mfma_f32_16x16x32_bf16 v[152:155], a[152:155], v[52:55], v[152:155]
  v_exp_f32 v33, v33
  v_mfma_f32_16x16x32_bf16 v[156:159], a[156:159], v[52:55], v[156:159]
  ds_read_b128 a[124:127], v4 offset:25344
  v_cvt_pk_bf16_f32 v38, v32, v33
  v_smfmac_f32_16x16x64_bf16 a[196:199], a[204:207], v[52:59], v7
  v_fma_f32 v45, v45, s36, v30
  v_mfma_f32_16x16x32_bf16 v[160:163], a[128:131], v[56:59], v[160:163]
  v_exp_f32 v42, v42
  v_mfma_f32_16x16x32_bf16 v[164:167], a[132:135], v[56:59], v[164:167]
  v_exp_f32 v34, v34
  v_mfma_f32_16x16x32_bf16 v[168:171], a[136:139], v[56:59], v[168:171]
  v_exp_f32 v43, v43
  v_mfma_f32_16x16x32_bf16 v[172:175], a[140:143], v[56:59], v[172:175]
  s_add_u32 m0, s32, 114688
  v_exp_f32 v35, v35
  v_mfma_f32_16x16x32_bf16 v[176:179], a[144:147], v[56:59], v[176:179]
  s_xor_b32 s35, s33, 57344
  v_cvt_pk_bf16_f32 v41, v42, v43
  v_cvt_pk_bf16_f32 v39, v34, v35
  v_mfma_f32_16x16x32_bf16 v[180:183], a[148:151], v[56:59], v[180:183]
  buffer_load_dwordx4 v2, s[20:23], s35 offen nt lds
  v_mfma_f32_16x16x32_bf16 v[184:187], a[152:155], v[56:59], v[184:187]
  v_exp_f32 v44, v44
  v_mfma_f32_16x16x32_bf16 v[188:191], a[156:159], v[56:59], v[188:191]
  s_waitcnt lgkmcnt(1)
  v_exp_f32 v45, v45
  v_mfma_f32_16x16x32_bf16 v[52:55], a[96:99], a[0:3], v[10:13]
  v_cvt_pk_bf16_f32 v42, v44, v45
  v_fma_f32 v46, v46, s36, v30
  v_mfma_f32_16x16x32_bf16 v[52:55], a[100:103], a[4:7], v[52:55]
  v_exp_f32 v46, v46
  v_mfma_f32_16x16x32_bf16 v[52:55], a[104:107], a[8:11], v[52:55]
  v_fma_f32 v47, v47, s36, v30
  v_mfma_f32_16x16x32_bf16 v[52:55], a[108:111], a[12:15], v[52:55]
  v_exp_f32 v47, v47
  v_mfma_f32_16x16x32_bf16 v[48:51], a[112:115], a[0:3], v[10:13]
  v_cvt_pk_bf16_f32 v43, v46, v47
  v_mfma_f32_16x16x32_bf16 v[48:51], a[116:119], a[4:7], v[48:51]
  v_exp_f32 v52, v52
  v_mfma_f32_16x16x32_bf16 v[48:51], a[120:123], a[8:11], v[48:51]
  s_waitcnt lgkmcnt(0)
  v_exp_f32 v53, v53
  v_mfma_f32_16x16x32_bf16 v[48:51], a[124:127], a[12:15], v[48:51]
  v_cvt_pk_bf16_f32 v52, v52, v53
  v_mfma_f32_16x16x32_bf16 v[56:59], a[96:99], a[16:19], v[14:17]
  v_exp_f32 v54, v54
  v_mfma_f32_16x16x32_bf16 v[56:59], a[100:103], a[20:23], v[56:59]
  v_exp_f32 v55, v55
  v_mfma_f32_16x16x32_bf16 v[56:59], a[104:107], a[24:27], v[56:59]
  v_cvt_pk_bf16_f32 v53, v54, v55
  v_mfma_f32_16x16x32_bf16 v[56:59], a[108:111], a[28:31], v[56:59]
  v_exp_f32 v48, v48
  v_mfma_f32_16x16x32_bf16 v[60:63], a[112:115], a[16:19], v[14:17]
  v_exp_f32 v49, v49
  v_mfma_f32_16x16x32_bf16 v[60:63], a[116:119], a[20:23], v[60:63]
  buffer_load_dwordx4 v2, s[20:23], s35 offen offset:1024 nt lds
  v_mfma_f32_16x16x32_bf16 v[60:63], a[120:123], a[24:27], v[60:63]
  v_exp_f32 v56, v56
  v_mfma_f32_16x16x32_bf16 v[60:63], a[124:127], a[28:31], v[60:63]
  v_exp_f32 v57, v57
  v_mfma_f32_16x16x32_bf16 v[192:195], a[128:131], v[36:39], v[192:195]
  v_cvt_pk_bf16_f32 v56, v56, v57
  v_cvt_pk_bf16_f32 v54, v48, v49
  v_mfma_f32_16x16x32_bf16 v[196:199], a[132:135], v[36:39], v[196:199]
  v_exp_f32 v58, v58
  v_mfma_f32_16x16x32_bf16 v[200:203], a[136:139], v[36:39], v[200:203]
  v_exp_f32 v50, v50
  v_mfma_f32_16x16x32_bf16 v[204:207], a[140:143], v[36:39], v[204:207]
  v_exp_f32 v59, v59
  v_mfma_f32_16x16x32_bf16 v[208:211], a[144:147], v[36:39], v[208:211]
  v_exp_f32 v51, v51
  v_mfma_f32_16x16x32_bf16 v[212:215], a[148:151], v[36:39], v[212:215]
  v_cvt_pk_bf16_f32 v57, v58, v59
  v_cvt_pk_bf16_f32 v55, v50, v51
  v_mfma_f32_16x16x32_bf16 v[216:219], a[152:155], v[36:39], v[216:219]
  v_exp_f32 v60, v60
  v_mfma_f32_16x16x32_bf16 v[220:223], a[156:159], v[36:39], v[220:223]
  v_exp_f32 v61, v61
  v_smfmac_f32_16x16x64_bf16 a[200:203], a[204:207], v[36:43], v7
  s_waitcnt vmcnt(6)
  s_barrier
  v_mfma_f32_16x16x32_bf16 v[224:227], a[128:131], v[40:43], v[224:227]
  ds_read_b64_tr_b16 a[128:129], v5 offset:18432
  ds_read_b64_tr_b16 a[130:131], v5 offset:26624
  v_mfma_f32_16x16x32_bf16 v[228:231], a[132:135], v[40:43], v[228:231]
  ds_read_b64_tr_b16 a[132:133], v6 offset:18432
  v_cvt_pk_bf16_f32 v58, v60, v61
  v_mfma_f32_16x16x32_bf16 v[232:235], a[136:139], v[40:43], v[232:235]
  ds_read_b64_tr_b16 a[134:135], v6 offset:26624
  ds_read_b64_tr_b16 a[136:137], v5 offset:18688
  v_mfma_f32_16x16x32_bf16 v[236:239], a[140:143], v[40:43], v[236:239]
  ds_read_b64_tr_b16 a[138:139], v5 offset:26880
  v_mfma_f32_16x16x32_bf16 v[240:243], a[144:147], v[40:43], v[240:243]
  buffer_load_dwordx4 v0, s[24:27], s35 offen offset:2048 nt lds
  v_mfma_f32_16x16x32_bf16 v[244:247], a[148:151], v[40:43], v[244:247]
  ds_read_b64_tr_b16 a[140:141], v6 offset:18688
  ds_read_b64_tr_b16 a[142:143], v6 offset:26880
  v_mfma_f32_16x16x32_bf16 v[248:251], a[152:155], v[40:43], v[248:251]
  ds_read_b64_tr_b16 a[144:145], v5 offset:18944
  v_mfma_f32_16x16x32_bf16 v[252:255], a[156:159], v[40:43], v[252:255]
  ds_read_b64_tr_b16 a[146:147], v5 offset:27136
  ds_read_b64_tr_b16 a[148:149], v6 offset:18944
  v_mfma_f32_16x16x32_bf16 v[36:39], a[96:99], a[32:35], v[18:21]
  ds_read_b64_tr_b16 a[150:151], v6 offset:27136
  v_mfma_f32_16x16x32_bf16 v[36:39], a[100:103], a[36:39], v[36:39]
  ds_read_b64_tr_b16 a[152:153], v5 offset:19200
  ds_read_b64_tr_b16 a[154:155], v5 offset:27392
  v_mfma_f32_16x16x32_bf16 v[36:39], a[104:107], a[40:43], v[36:39]
  ds_read_b64_tr_b16 a[156:157], v6 offset:19200
  v_mfma_f32_16x16x32_bf16 v[36:39], a[108:111], a[44:47], v[36:39]
  v_exp_f32 v62, v62
  v_mfma_f32_16x16x32_bf16 v[32:35], a[112:115], a[32:35], v[18:21]
  v_exp_f32 v63, v63
  v_mfma_f32_16x16x32_bf16 v[32:35], a[116:119], a[36:39], v[32:35]
  ds_read_b64_tr_b16 a[158:159], v6 offset:27392
  v_cvt_pk_bf16_f32 v59, v62, v63
  v_mfma_f32_16x16x32_bf16 v[32:35], a[120:123], a[40:43], v[32:35]
  v_exp_f32 v36, v36
  v_mfma_f32_16x16x32_bf16 v[32:35], a[124:127], a[44:47], v[32:35]
  v_exp_f32 v37, v37
  v_mfma_f32_16x16x32_bf16 v[40:43], a[96:99], a[48:51], v[22:25]
  v_cvt_pk_bf16_f32 v36, v36, v37
  v_mfma_f32_16x16x32_bf16 v[40:43], a[100:103], a[52:55], v[40:43]
  v_exp_f32 v38, v38
  v_mfma_f32_16x16x32_bf16 v[40:43], a[104:107], a[56:59], v[40:43]
  v_exp_f32 v39, v39
  v_mfma_f32_16x16x32_bf16 v[40:43], a[108:111], a[60:63], v[40:43]
  v_cvt_pk_bf16_f32 v37, v38, v39
  v_mfma_f32_16x16x32_bf16 v[44:47], a[112:115], a[48:51], v[22:25]
  buffer_load_dwordx4 v1, s[24:27], s35 offen offset:3072 nt lds
  v_mfma_f32_16x16x32_bf16 v[44:47], a[116:119], a[52:55], v[44:47]
  v_exp_f32 v40, v40
  v_mfma_f32_16x16x32_bf16 v[44:47], a[120:123], a[56:59], v[44:47]
  v_exp_f32 v32, v32
  v_mfma_f32_16x16x32_bf16 v[44:47], a[124:127], a[60:63], v[44:47]
  s_waitcnt lgkmcnt(0)
  v_exp_f32 v41, v41
  v_mfma_f32_16x16x32_bf16 v[64:67], a[128:131], v[52:55], v[64:67]
  v_exp_f32 v33, v33
  v_mfma_f32_16x16x32_bf16 v[68:71], a[132:135], v[52:55], v[68:71]
  v_cvt_pk_bf16_f32 v40, v40, v41
  v_cvt_pk_bf16_f32 v38, v32, v33
  v_mfma_f32_16x16x32_bf16 v[72:75], a[136:139], v[52:55], v[72:75]
  v_exp_f32 v42, v42
  v_mfma_f32_16x16x32_bf16 v[76:79], a[140:143], v[52:55], v[76:79]
  v_exp_f32 v34, v34
  v_mfma_f32_16x16x32_bf16 v[80:83], a[144:147], v[52:55], v[80:83]
  v_exp_f32 v43, v43
  v_mfma_f32_16x16x32_bf16 v[84:87], a[148:151], v[52:55], v[84:87]
  v_exp_f32 v35, v35
  v_mfma_f32_16x16x32_bf16 v[88:91], a[152:155], v[52:55], v[88:91]
  v_cvt_pk_bf16_f32 v41, v42, v43
  v_cvt_pk_bf16_f32 v39, v34, v35
  v_mfma_f32_16x16x32_bf16 v[92:95], a[156:159], v[52:55], v[92:95]
  v_exp_f32 v44, v44
  v_smfmac_f32_16x16x64_bf16 a[192:195], a[204:207], v[52:59], v7
  v_mfma_f32_16x16x32_bf16 v[96:99], a[128:131], v[56:59], v[96:99]
  v_exp_f32 v45, v45
  v_mfma_f32_16x16x32_bf16 v[100:103], a[132:135], v[56:59], v[100:103]
  s_add_u32 m0, s32, 131072
  v_exp_f32 v46, v46
  v_mfma_f32_16x16x32_bf16 v[104:107], a[136:139], v[56:59], v[104:107]
  s_xor_b32 s35, s33, 65536
  v_exp_f32 v47, v47
  v_mfma_f32_16x16x32_bf16 v[108:111], a[140:143], v[56:59], v[108:111]
  buffer_load_dwordx4 v2, s[20:23], s35 offen nt lds
  v_mfma_f32_16x16x32_bf16 v[112:115], a[144:147], v[56:59], v[112:115]
  v_cvt_pk_bf16_f32 v42, v44, v45
  v_cvt_pk_bf16_f32 v43, v46, v47
  v_mfma_f32_16x16x32_bf16 v[116:119], a[148:151], v[56:59], v[116:119]
  v_mfma_f32_16x16x32_bf16 v[120:123], a[152:155], v[56:59], v[120:123]
  v_mfma_f32_16x16x32_bf16 v[124:127], a[156:159], v[56:59], v[124:127]
  v_mfma_f32_16x16x32_bf16 v[52:55], a[96:99], a[64:67], v[26:29]
  v_mfma_f32_16x16x32_bf16 v[52:55], a[100:103], a[68:71], v[52:55]
  v_mfma_f32_16x16x32_bf16 v[52:55], a[104:107], a[72:75], v[52:55]
  v_mfma_f32_16x16x32_bf16 v[52:55], a[108:111], a[76:79], v[52:55]
  v_mfma_f32_16x16x32_bf16 v[48:51], a[112:115], a[64:67], v[26:29]
  v_mfma_f32_16x16x32_bf16 v[48:51], a[116:119], a[68:71], v[48:51]
  v_exp_f32 v52, v52
  v_mfma_f32_16x16x32_bf16 v[48:51], a[120:123], a[72:75], v[48:51]
  v_exp_f32 v53, v53
  v_mfma_f32_16x16x32_bf16 v[48:51], a[124:127], a[76:79], v[48:51]
  s_waitcnt vmcnt(5)
  s_barrier
  v_mfma_f32_16x16x32_bf16 v[56:59], a[96:99], a[80:83], 0
  ds_read_b128 a[96:99], v4 offset:32768
  v_cvt_pk_bf16_f32 v52, v52, v53
  v_mfma_f32_16x16x32_bf16 v[56:59], a[100:103], a[84:87], v[56:59]
  v_exp_f32 v54, v54
  v_mfma_f32_16x16x32_bf16 v[56:59], a[104:107], a[88:91], v[56:59]
  ds_read_b128 a[100:103], v4 offset:33024
  v_mfma_f32_16x16x32_bf16 v[56:59], a[108:111], a[92:95], v[56:59]
  buffer_load_dwordx4 v2, s[20:23], s35 offen offset:1024 nt lds
  v_mfma_f32_16x16x32_bf16 v[60:63], a[112:115], a[80:83], 0
  ds_read_b128 a[104:107], v4 offset:33280
  v_mfma_f32_16x16x32_bf16 v[60:63], a[116:119], a[84:87], v[60:63]
  v_exp_f32 v55, v55
  v_mfma_f32_16x16x32_bf16 v[60:63], a[120:123], a[88:91], v[60:63]
  ds_read_b128 a[108:111], v4 offset:33536
  v_cvt_pk_bf16_f32 v53, v54, v55
  v_mfma_f32_16x16x32_bf16 v[60:63], a[124:127], a[92:95], v[60:63]
  v_fma_f32 v56, v56, s36, v30
  v_fma_f32 v57, v57, s36, v30
  v_mfma_f32_16x16x32_bf16 v[128:131], a[128:131], v[36:39], v[128:131]
  ds_read_b128 a[112:115], v4 offset:40960
  v_fma_f32 v58, v58, s36, v30
  v_mfma_f32_16x16x32_bf16 v[132:135], a[132:135], v[36:39], v[132:135]
  v_exp_f32 v56, v56
  v_mfma_f32_16x16x32_bf16 v[136:139], a[136:139], v[36:39], v[136:139]
  ds_read_b128 a[116:119], v4 offset:41216
  v_fma_f32 v59, v59, s36, v30
  v_mfma_f32_16x16x32_bf16 v[140:143], a[140:143], v[36:39], v[140:143]
  v_exp_f32 v48, v48
  v_mfma_f32_16x16x32_bf16 v[144:147], a[144:147], v[36:39], v[144:147]
  ds_read_b128 a[120:123], v4 offset:41472
  v_fma_f32 v60, v60, s36, v30
  v_mfma_f32_16x16x32_bf16 v[148:151], a[148:151], v[36:39], v[148:151]
  v_exp_f32 v57, v57
  v_mfma_f32_16x16x32_bf16 v[152:155], a[152:155], v[36:39], v[152:155]
  ds_read_b128 a[124:127], v4 offset:41728
  v_cvt_pk_bf16_f32 v56, v56, v57
  v_mfma_f32_16x16x32_bf16 v[156:159], a[156:159], v[36:39], v[156:159]
  v_exp_f32 v49, v49
  v_smfmac_f32_16x16x64_bf16 a[196:199], a[204:207], v[36:43], v7
  v_cvt_pk_bf16_f32 v54, v48, v49
  v_mfma_f32_16x16x32_bf16 v[160:163], a[128:131], v[40:43], v[160:163]
  v_exp_f32 v58, v58
  v_mfma_f32_16x16x32_bf16 v[164:167], a[132:135], v[40:43], v[164:167]
  v_exp_f32 v50, v50
  v_mfma_f32_16x16x32_bf16 v[168:171], a[136:139], v[40:43], v[168:171]
  buffer_load_dwordx4 v0, s[24:27], s35 offen offset:2048 nt lds
  v_mfma_f32_16x16x32_bf16 v[172:175], a[140:143], v[40:43], v[172:175]
  v_exp_f32 v59, v59
  v_mfma_f32_16x16x32_bf16 v[176:179], a[144:147], v[40:43], v[176:179]
  v_exp_f32 v51, v51
  v_mfma_f32_16x16x32_bf16 v[180:183], a[148:151], v[40:43], v[180:183]
  v_cvt_pk_bf16_f32 v57, v58, v59
  v_cvt_pk_bf16_f32 v55, v50, v51
  v_mfma_f32_16x16x32_bf16 v[184:187], a[152:155], v[40:43], v[184:187]
  v_fma_f32 v61, v61, s36, v30
  v_fma_f32 v62, v62, s36, v30
  v_mfma_f32_16x16x32_bf16 v[188:191], a[156:159], v[40:43], v[188:191]
  s_waitcnt lgkmcnt(0)
  v_exp_f32 v60, v60
  v_mfma_f32_16x16x32_bf16 v[36:39], a[96:99], a[0:3], v[10:13]
  v_exp_f32 v61, v61
  v_mfma_f32_16x16x32_bf16 v[36:39], a[100:103], a[4:7], v[36:39]
  v_cvt_pk_bf16_f32 v58, v60, v61
  v_fma_f32 v63, v63, s36, v30
  v_mfma_f32_16x16x32_bf16 v[36:39], a[104:107], a[8:11], v[36:39]
  v_exp_f32 v62, v62
  v_mfma_f32_16x16x32_bf16 v[36:39], a[108:111], a[12:15], v[36:39]
  v_exp_f32 v63, v63
  v_mfma_f32_16x16x32_bf16 v[32:35], a[112:115], a[0:3], v[10:13]
  v_cvt_pk_bf16_f32 v59, v62, v63
  v_mfma_f32_16x16x32_bf16 v[32:35], a[116:119], a[4:7], v[32:35]
  v_exp_f32 v36, v36
  v_mfma_f32_16x16x32_bf16 v[32:35], a[120:123], a[8:11], v[32:35]
  v_exp_f32 v37, v37
  v_mfma_f32_16x16x32_bf16 v[32:35], a[124:127], a[12:15], v[32:35]
  v_cvt_pk_bf16_f32 v36, v36, v37
  v_mfma_f32_16x16x32_bf16 v[40:43], a[96:99], a[16:19], v[14:17]
  v_exp_f32 v38, v38
  v_mfma_f32_16x16x32_bf16 v[40:43], a[100:103], a[20:23], v[40:43]
  v_exp_f32 v39, v39
  v_mfma_f32_16x16x32_bf16 v[40:43], a[104:107], a[24:27], v[40:43]
  buffer_load_dwordx4 v1, s[24:27], s35 offen offset:3072 nt lds
  v_mfma_f32_16x16x32_bf16 v[40:43], a[108:111], a[28:31], v[40:43]
  v_cvt_pk_bf16_f32 v37, v38, v39
  v_mfma_f32_16x16x32_bf16 v[44:47], a[112:115], a[16:19], v[14:17]
  v_exp_f32 v32, v32
  v_mfma_f32_16x16x32_bf16 v[44:47], a[116:119], a[20:23], v[44:47]
  v_exp_f32 v40, v40
  v_mfma_f32_16x16x32_bf16 v[44:47], a[120:123], a[24:27], v[44:47]
  v_exp_f32 v41, v41
  v_mfma_f32_16x16x32_bf16 v[44:47], a[124:127], a[28:31], v[44:47]
  v_exp_f32 v33, v33
  v_mfma_f32_16x16x32_bf16 v[192:195], a[128:131], v[52:55], v[192:195]
  v_cvt_pk_bf16_f32 v40, v40, v41
  v_cvt_pk_bf16_f32 v38, v32, v33
  v_mfma_f32_16x16x32_bf16 v[196:199], a[132:135], v[52:55], v[196:199]
  v_exp_f32 v42, v42
  v_mfma_f32_16x16x32_bf16 v[200:203], a[136:139], v[52:55], v[200:203]
  v_exp_f32 v34, v34
  v_mfma_f32_16x16x32_bf16 v[204:207], a[140:143], v[52:55], v[204:207]
  v_exp_f32 v43, v43
  v_mfma_f32_16x16x32_bf16 v[208:211], a[144:147], v[52:55], v[208:211]
  v_exp_f32 v35, v35
  v_mfma_f32_16x16x32_bf16 v[212:215], a[148:151], v[52:55], v[212:215]
  v_cvt_pk_bf16_f32 v41, v42, v43
  v_cvt_pk_bf16_f32 v39, v34, v35
  v_mfma_f32_16x16x32_bf16 v[216:219], a[152:155], v[52:55], v[216:219]
  v_exp_f32 v44, v44
  v_mfma_f32_16x16x32_bf16 v[220:223], a[156:159], v[52:55], v[220:223]
  v_exp_f32 v45, v45
  v_smfmac_f32_16x16x64_bf16 a[200:203], a[204:207], v[52:59], v7
  s_add_u32 m0, s32, 147456
  v_cvt_pk_bf16_f32 v42, v44, v45
  v_mfma_f32_16x16x32_bf16 v[224:227], a[128:131], v[56:59], v[224:227]
  s_xor_b32 s35, s33, 73728
  ds_read_b64_tr_b16 a[128:129], v5 offset:34816
  ds_read_b64_tr_b16 a[130:131], v5 offset:43008
  v_mfma_f32_16x16x32_bf16 v[228:231], a[132:135], v[56:59], v[228:231]
  buffer_load_dwordx4 v2, s[20:23], s35 offen nt lds
  v_mfma_f32_16x16x32_bf16 v[232:235], a[136:139], v[56:59], v[232:235]
  ds_read_b64_tr_b16 a[132:133], v6 offset:34816
  ds_read_b64_tr_b16 a[134:135], v6 offset:43008
  v_mfma_f32_16x16x32_bf16 v[236:239], a[140:143], v[56:59], v[236:239]
  ds_read_b64_tr_b16 a[136:137], v5 offset:35072
  v_mfma_f32_16x16x32_bf16 v[240:243], a[144:147], v[56:59], v[240:243]
  ds_read_b64_tr_b16 a[138:139], v5 offset:43264
  ds_read_b64_tr_b16 a[140:141], v6 offset:35072
  v_mfma_f32_16x16x32_bf16 v[244:247], a[148:151], v[56:59], v[244:247]
  ds_read_b64_tr_b16 a[142:143], v6 offset:43264
  v_mfma_f32_16x16x32_bf16 v[248:251], a[152:155], v[56:59], v[248:251]
  ds_read_b64_tr_b16 a[144:145], v5 offset:35328
  ds_read_b64_tr_b16 a[146:147], v5 offset:43520
  v_mfma_f32_16x16x32_bf16 v[252:255], a[156:159], v[56:59], v[252:255]
  ds_read_b64_tr_b16 a[148:149], v6 offset:35328
  v_mfma_f32_16x16x32_bf16 v[52:55], a[96:99], a[32:35], v[18:21]
  ds_read_b64_tr_b16 a[150:151], v6 offset:43520
  ds_read_b64_tr_b16 a[152:153], v5 offset:35584
  v_mfma_f32_16x16x32_bf16 v[52:55], a[100:103], a[36:39], v[52:55]
  ds_read_b64_tr_b16 a[154:155], v5 offset:43776
  v_mfma_f32_16x16x32_bf16 v[52:55], a[104:107], a[40:43], v[52:55]
  ds_read_b64_tr_b16 a[156:157], v6 offset:35584
  ds_read_b64_tr_b16 a[158:159], v6 offset:43776
  v_mfma_f32_16x16x32_bf16 v[52:55], a[108:111], a[44:47], v[52:55]
  v_exp_f32 v46, v46
  v_mfma_f32_16x16x32_bf16 v[48:51], a[112:115], a[32:35], v[18:21]
  v_exp_f32 v47, v47
  v_mfma_f32_16x16x32_bf16 v[48:51], a[116:119], a[36:39], v[48:51]
  v_exp_f32 v52, v52
  v_mfma_f32_16x16x32_bf16 v[48:51], a[120:123], a[40:43], v[48:51]
  v_exp_f32 v53, v53
  v_mfma_f32_16x16x32_bf16 v[48:51], a[124:127], a[44:47], v[48:51]
  v_cvt_pk_bf16_f32 v43, v46, v47
  v_cvt_pk_bf16_f32 v52, v52, v53
  v_mfma_f32_16x16x32_bf16 v[56:59], a[96:99], a[48:51], v[22:25]
  v_exp_f32 v54, v54
  v_mfma_f32_16x16x32_bf16 v[56:59], a[100:103], a[52:55], v[56:59]
  buffer_load_dwordx4 v2, s[20:23], s35 offen offset:1024 nt lds
  v_mfma_f32_16x16x32_bf16 v[56:59], a[104:107], a[56:59], v[56:59]
  v_exp_f32 v55, v55
  v_mfma_f32_16x16x32_bf16 v[56:59], a[108:111], a[60:63], v[56:59]
  v_cvt_pk_bf16_f32 v53, v54, v55
  v_mfma_f32_16x16x32_bf16 v[60:63], a[112:115], a[48:51], v[22:25]
  v_exp_f32 v48, v48
  v_mfma_f32_16x16x32_bf16 v[60:63], a[116:119], a[52:55], v[60:63]
  v_exp_f32 v56, v56
  v_mfma_f32_16x16x32_bf16 v[60:63], a[120:123], a[56:59], v[60:63]
  v_exp_f32 v57, v57
  v_mfma_f32_16x16x32_bf16 v[60:63], a[124:127], a[60:63], v[60:63]
  s_waitcnt lgkmcnt(0)
  v_exp_f32 v49, v49
  v_mfma_f32_16x16x32_bf16 v[64:67], a[128:131], v[36:39], v[64:67]
  v_cvt_pk_bf16_f32 v56, v56, v57
  v_cvt_pk_bf16_f32 v54, v48, v49
  v_mfma_f32_16x16x32_bf16 v[68:71], a[132:135], v[36:39], v[68:71]
  v_exp_f32 v58, v58
  v_mfma_f32_16x16x32_bf16 v[72:75], a[136:139], v[36:39], v[72:75]
  v_exp_f32 v50, v50
  v_mfma_f32_16x16x32_bf16 v[76:79], a[140:143], v[36:39], v[76:79]
  v_exp_f32 v59, v59
  v_mfma_f32_16x16x32_bf16 v[80:83], a[144:147], v[36:39], v[80:83]
  v_exp_f32 v51, v51
  v_mfma_f32_16x16x32_bf16 v[84:87], a[148:151], v[36:39], v[84:87]
  v_cvt_pk_bf16_f32 v57, v58, v59
  v_cvt_pk_bf16_f32 v55, v50, v51
  v_mfma_f32_16x16x32_bf16 v[88:91], a[152:155], v[36:39], v[88:91]
  v_exp_f32 v60, v60
  v_mfma_f32_16x16x32_bf16 v[92:95], a[156:159], v[36:39], v[92:95]
  v_exp_f32 v61, v61
  v_smfmac_f32_16x16x64_bf16 a[192:195], a[204:207], v[36:43], v7
  v_cvt_pk_bf16_f32 v58, v60, v61
  v_mfma_f32_16x16x32_bf16 v[96:99], a[128:131], v[40:43], v[96:99]
  buffer_load_dwordx4 v0, s[24:27], s35 offen offset:2048 nt lds
  v_mfma_f32_16x16x32_bf16 v[100:103], a[132:135], v[40:43], v[100:103]
  v_exp_f32 v62, v62
  v_mfma_f32_16x16x32_bf16 v[104:107], a[136:139], v[40:43], v[104:107]
  v_exp_f32 v63, v63
  v_mfma_f32_16x16x32_bf16 v[108:111], a[140:143], v[40:43], v[108:111]
  v_cvt_pk_bf16_f32 v59, v62, v63
  v_mfma_f32_16x16x32_bf16 v[112:115], a[144:147], v[40:43], v[112:115]
  v_mfma_f32_16x16x32_bf16 v[116:119], a[148:151], v[40:43], v[116:119]
  v_mfma_f32_16x16x32_bf16 v[120:123], a[152:155], v[40:43], v[120:123]
  v_mfma_f32_16x16x32_bf16 v[124:127], a[156:159], v[40:43], v[124:127]
  v_mfma_f32_16x16x32_bf16 v[36:39], a[96:99], a[64:67], v[26:29]
  v_mfma_f32_16x16x32_bf16 v[36:39], a[100:103], a[68:71], v[36:39]
  v_mfma_f32_16x16x32_bf16 v[36:39], a[104:107], a[72:75], v[36:39]
  v_mfma_f32_16x16x32_bf16 v[36:39], a[108:111], a[76:79], v[36:39]
  v_mfma_f32_16x16x32_bf16 v[32:35], a[112:115], a[64:67], v[26:29]
  v_mfma_f32_16x16x32_bf16 v[32:35], a[116:119], a[68:71], v[32:35]
  v_exp_f32 v36, v36
  v_mfma_f32_16x16x32_bf16 v[32:35], a[120:123], a[72:75], v[32:35]
  v_exp_f32 v37, v37
  v_mfma_f32_16x16x32_bf16 v[32:35], a[124:127], a[76:79], v[32:35]
  s_waitcnt vmcnt(5)
  s_barrier
  v_mfma_f32_16x16x32_bf16 v[40:43], a[96:99], a[80:83], 0
  buffer_load_dwordx4 v1, s[24:27], s35 offen offset:3072 nt lds
  v_mfma_f32_16x16x32_bf16 v[40:43], a[100:103], a[84:87], v[40:43]
  ds_read_b128 a[96:99], v4 offset:49152
  v_cvt_pk_bf16_f32 v36, v36, v37
  v_mfma_f32_16x16x32_bf16 v[40:43], a[104:107], a[88:91], v[40:43]
  v_exp_f32 v38, v38
  v_mfma_f32_16x16x32_bf16 v[40:43], a[108:111], a[92:95], v[40:43]
  ds_read_b128 a[100:103], v4 offset:49408
  v_mfma_f32_16x16x32_bf16 v[44:47], a[112:115], a[80:83], 0
  v_exp_f32 v39, v39
  v_mfma_f32_16x16x32_bf16 v[44:47], a[116:119], a[84:87], v[44:47]
  ds_read_b128 a[104:107], v4 offset:49664
  v_cvt_pk_bf16_f32 v37, v38, v39
  v_mfma_f32_16x16x32_bf16 v[44:47], a[120:123], a[88:91], v[44:47]
  v_fma_f32 v40, v40, s36, v30
  v_fma_f32 v41, v41, s36, v30
  v_mfma_f32_16x16x32_bf16 v[44:47], a[124:127], a[92:95], v[44:47]
  ds_read_b128 a[108:111], v4 offset:49920
  v_fma_f32 v42, v42, s36, v30
  v_mfma_f32_16x16x32_bf16 v[128:131], a[128:131], v[52:55], v[128:131]
  v_exp_f32 v40, v40
  v_mfma_f32_16x16x32_bf16 v[132:135], a[132:135], v[52:55], v[132:135]
  ds_read_b128 a[112:115], v4 offset:57344
  v_fma_f32 v43, v43, s36, v30
  v_mfma_f32_16x16x32_bf16 v[136:139], a[136:139], v[52:55], v[136:139]
  v_exp_f32 v32, v32
  v_mfma_f32_16x16x32_bf16 v[140:143], a[140:143], v[52:55], v[140:143]
  ds_read_b128 a[116:119], v4 offset:57600
  v_fma_f32 v44, v44, s36, v30
  v_mfma_f32_16x16x32_bf16 v[144:147], a[144:147], v[52:55], v[144:147]
  v_exp_f32 v41, v41
  v_mfma_f32_16x16x32_bf16 v[148:151], a[148:151], v[52:55], v[148:151]
  ds_read_b128 a[120:123], v4 offset:57856
  v_cvt_pk_bf16_f32 v40, v40, v41
  v_mfma_f32_16x16x32_bf16 v[152:155], a[152:155], v[52:55], v[152:155]
  s_add_u32 m0, s32, 0
  v_exp_f32 v33, v33
  v_mfma_f32_16x16x32_bf16 v[156:159], a[156:159], v[52:55], v[156:159]
  s_xor_b32 s35, s33, 81920
  ds_read_b128 a[124:127], v4 offset:58112
  v_cvt_pk_bf16_f32 v38, v32, v33
  v_smfmac_f32_16x16x64_bf16 a[196:199], a[204:207], v[52:59], v7
  v_fma_f32 v45, v45, s36, v30
  v_mfma_f32_16x16x32_bf16 v[160:163], a[128:131], v[56:59], v[160:163]
  buffer_load_dwordx4 v2, s[20:23], s35 offen nt lds
  v_mfma_f32_16x16x32_bf16 v[164:167], a[132:135], v[56:59], v[164:167]
  v_exp_f32 v42, v42
  v_mfma_f32_16x16x32_bf16 v[168:171], a[136:139], v[56:59], v[168:171]
  v_exp_f32 v34, v34
  v_mfma_f32_16x16x32_bf16 v[172:175], a[140:143], v[56:59], v[172:175]
  v_exp_f32 v43, v43
  v_mfma_f32_16x16x32_bf16 v[176:179], a[144:147], v[56:59], v[176:179]
  v_exp_f32 v35, v35
  v_mfma_f32_16x16x32_bf16 v[180:183], a[148:151], v[56:59], v[180:183]
  v_cvt_pk_bf16_f32 v41, v42, v43
  v_cvt_pk_bf16_f32 v39, v34, v35
  v_mfma_f32_16x16x32_bf16 v[184:187], a[152:155], v[56:59], v[184:187]
  v_exp_f32 v44, v44
  v_mfma_f32_16x16x32_bf16 v[188:191], a[156:159], v[56:59], v[188:191]
  s_waitcnt lgkmcnt(1)
  v_exp_f32 v45, v45
  v_mfma_f32_16x16x32_bf16 v[52:55], a[96:99], a[32:35], v[18:21]
  v_cvt_pk_bf16_f32 v42, v44, v45
  v_fma_f32 v46, v46, s36, v30
  v_mfma_f32_16x16x32_bf16 v[52:55], a[100:103], a[36:39], v[52:55]
  v_fma_f32 v47, v47, s36, v30
  v_add_u32 v4, 0x10000, v4
  v_mfma_f32_16x16x32_bf16 v[52:55], a[104:107], a[40:43], v[52:55]
  v_exp_f32 v46, v46
  v_mfma_f32_16x16x32_bf16 v[52:55], a[108:111], a[44:47], v[52:55]
  v_exp_f32 v47, v47
  v_mfma_f32_16x16x32_bf16 v[48:51], a[112:115], a[32:35], v[18:21]
  v_cvt_pk_bf16_f32 v43, v46, v47
  v_mfma_f32_16x16x32_bf16 v[48:51], a[116:119], a[36:39], v[48:51]
  v_exp_f32 v52, v52
  v_mfma_f32_16x16x32_bf16 v[48:51], a[120:123], a[40:43], v[48:51]
  s_waitcnt lgkmcnt(0)
  v_exp_f32 v53, v53
  v_mfma_f32_16x16x32_bf16 v[48:51], a[124:127], a[44:47], v[48:51]
  buffer_load_dwordx4 v2, s[20:23], s35 offen offset:1024 nt lds
  v_mfma_f32_16x16x32_bf16 v[56:59], a[96:99], a[48:51], v[22:25]
  v_cvt_pk_bf16_f32 v52, v52, v53
  v_mfma_f32_16x16x32_bf16 v[56:59], a[100:103], a[52:55], v[56:59]
L_isl4:
  s_cbranch_execz L_retA
  v_exp_f32 v54, v54
  v_mfma_f32_16x16x32_bf16 v[56:59], a[104:107], a[56:59], v[56:59]
  v_exp_f32 v55, v55
  v_mfma_f32_16x16x32_bf16 v[56:59], a[108:111], a[60:63], v[56:59]
  v_cvt_pk_bf16_f32 v53, v54, v55
  v_mfma_f32_16x16x32_bf16 v[60:63], a[112:115], a[48:51], v[22:25]
  v_exp_f32 v48, v48
  v_mfma_f32_16x16x32_bf16 v[60:63], a[116:119], a[52:55], v[60:63]
  v_exp_f32 v56, v56
  v_mfma_f32_16x16x32_bf16 v[60:63], a[120:123], a[56:59], v[60:63]
  v_exp_f32 v57, v57
  v_mfma_f32_16x16x32_bf16 v[60:63], a[124:127], a[60:63], v[60:63]
  v_exp_f32 v49, v49
  v_mfma_f32_16x16x32_bf16 v[192:195], a[128:131], v[36:39], v[192:195]
  v_cvt_pk_bf16_f32 v56, v56, v57
  v_cvt_pk_bf16_f32 v54, v48, v49
  v_mfma_f32_16x16x32_bf16 v[196:199], a[132:135], v[36:39], v[196:199]
  v_exp_f32 v58, v58
  v_mfma_f32_16x16x32_bf16 v[200:203], a[136:139], v[36:39], v[200:203]
  v_exp_f32 v50, v50
  v_mfma_f32_16x16x32_bf16 v[204:207], a[140:143], v[36:39], v[204:207]
  v_exp_f32 v59, v59
  v_mfma_f32_16x16x32_bf16 v[208:211], a[144:147], v[36:39], v[208:211]
  v_exp_f32 v51, v51
  v_mfma_f32_16x16x32_bf16 v[212:215], a[148:151], v[36:39], v[212:215]
  v_cvt_pk_bf16_f32 v57, v58, v59
  v_cvt_pk_bf16_f32 v55, v50, v51
  v_mfma_f32_16x16x32_bf16 v[216:219], a[152:155], v[36:39], v[216:219]
  v_exp_f32 v60, v60
  v_mfma_f32_16x16x32_bf16 v[220:223], a[156:159], v[36:39], v[220:223]
  buffer_load_dwordx4 v0, s[24:27], s35 offen offset:2048 nt lds
  v_smfmac_f32_16x16x64_bf16 a[200:203], a[204:207], v[36:43], v7
  v_mfma_f32_16x16x32_bf16 v[224:227], a[128:131], v[40:43], v[224:227]
  ds_read_b64_tr_b16 a[128:129], v5 offset:51200
  ds_read_b64_tr_b16 a[130:131], v5 offset:59392
  v_mfma_f32_16x16x32_bf16 v[228:231], a[132:135], v[40:43], v[228:231]
  ds_read_b64_tr_b16 a[132:133], v6 offset:51200
  v_mfma_f32_16x16x32_bf16 v[232:235], a[136:139], v[40:43], v[232:235]
  ds_read_b64_tr_b16 a[134:135], v6 offset:59392
  ds_read_b64_tr_b16 a[136:137], v5 offset:51456
  v_mfma_f32_16x16x32_bf16 v[236:239], a[140:143], v[40:43], v[236:239]
  ds_read_b64_tr_b16 a[138:139], v5 offset:59648
  v_mfma_f32_16x16x32_bf16 v[240:243], a[144:147], v[40:43], v[240:243]
  ds_read_b64_tr_b16 a[140:141], v6 offset:51456
  ds_read_b64_tr_b16 a[142:143], v6 offset:59648
  v_mfma_f32_16x16x32_bf16 v[244:247], a[148:151], v[40:43], v[244:247]
  ds_read_b64_tr_b16 a[144:145], v5 offset:51712
  v_mfma_f32_16x16x32_bf16 v[248:251], a[152:155], v[40:43], v[248:251]
  ds_read_b64_tr_b16 a[146:147], v5 offset:59904
  ds_read_b64_tr_b16 a[148:149], v6 offset:51712
  v_mfma_f32_16x16x32_bf16 v[252:255], a[156:159], v[40:43], v[252:255]
  ds_read_b64_tr_b16 a[150:151], v6 offset:59904
  v_mfma_f32_16x16x32_bf16 v[36:39], a[96:99], a[64:67], v[26:29]
  ds_read_b64_tr_b16 a[152:153], v5 offset:51968
  ds_read_b64_tr_b16 a[154:155], v5 offset:60160
  v_mfma_f32_16x16x32_bf16 v[36:39], a[100:103], a[68:71], v[36:39]
  ds_read_b64_tr_b16 a[156:157], v6 offset:51968
  v_mfma_f32_16x16x32_bf16 v[36:39], a[104:107], a[72:75], v[36:39]
  ds_read_b64_tr_b16 a[158:159], v6 offset:60160
  v_add_u32 v5, 0x10000, v5
  v_mfma_f32_16x16x32_bf16 v[36:39], a[108:111], a[76:79], v[36:39]
  v_exp_f32 v61, v61
  v_mfma_f32_16x16x32_bf16 v[32:35], a[112:115], a[64:67], v[26:29]
  v_cvt_pk_bf16_f32 v58, v60, v61
  v_add_u32 v6, 0x10000, v6
  v_mfma_f32_16x16x32_bf16 v[32:35], a[116:119], a[68:71], v[32:35]
  v_exp_f32 v62, v62
  v_mfma_f32_16x16x32_bf16 v[32:35], a[120:123], a[72:75], v[32:35]
  buffer_load_dwordx4 v1, s[24:27], s35 offen offset:3072 nt lds
  v_mfma_f32_16x16x32_bf16 v[32:35], a[124:127], a[76:79], v[32:35]
  v_exp_f32 v63, v63
  v_mfma_f32_16x16x32_bf16 v[40:43], a[96:99], a[80:83], 0
  ds_read_b128 a[96:99], v4 offset:0
  v_cvt_pk_bf16_f32 v59, v62, v63
  v_mfma_f32_16x16x32_bf16 v[40:43], a[100:103], a[84:87], v[40:43]
  v_exp_f32 v36, v36
  v_mfma_f32_16x16x32_bf16 v[40:43], a[104:107], a[88:91], v[40:43]
  ds_read_b128 a[100:103], v4 offset:256
  v_mfma_f32_16x16x32_bf16 v[40:43], a[108:111], a[92:95], v[40:43]
  v_exp_f32 v37, v37
  v_mfma_f32_16x16x32_bf16 v[44:47], a[112:115], a[80:83], 0
  ds_read_b128 a[104:107], v4 offset:512
  v_cvt_pk_bf16_f32 v36, v36, v37
  v_mfma_f32_16x16x32_bf16 v[44:47], a[116:119], a[84:87], v[44:47]
  v_exp_f32 v38, v38
  v_mfma_f32_16x16x32_bf16 v[44:47], a[120:123], a[88:91], v[44:47]
  ds_read_b128 a[108:111], v4 offset:768
  v_fma_f32 v40, v40, s36, v30
  v_mfma_f32_16x16x32_bf16 v[44:47], a[124:127], a[92:95], v[44:47]
  s_waitcnt lgkmcnt(4)
  v_exp_f32 v39, v39
  v_mfma_f32_16x16x32_bf16 v[128:131], a[128:131], v[52:55], v[128:131]
  ds_read_b128 a[112:115], v4 offset:8192
  v_cvt_pk_bf16_f32 v37, v38, v39
  v_mfma_f32_16x16x32_bf16 v[132:135], a[132:135], v[52:55], v[132:135]
  v_fma_f32 v41, v41, s36, v30
  v_fma_f32 v42, v42, s36, v30
  v_mfma_f32_16x16x32_bf16 v[136:139], a[136:139], v[52:55], v[136:139]
  ds_read_b128 a[116:119], v4 offset:8448
  v_fma_f32 v43, v43, s36, v30
  v_mfma_f32_16x16x32_bf16 v[140:143], a[140:143], v[52:55], v[140:143]
  v_exp_f32 v40, v40
  v_mfma_f32_16x16x32_bf16 v[144:147], a[144:147], v[52:55], v[144:147]
  s_add_u32 m0, s32, 16384
  ds_read_b128 a[120:123], v4 offset:8704
  v_fma_f32 v44, v44, s36, v30
  v_mfma_f32_16x16x32_bf16 v[148:151], a[148:151], v[52:55], v[148:151]
  s_xor_b32 s35, s33, 90112
  v_exp_f32 v32, v32
  v_mfma_f32_16x16x32_bf16 v[152:155], a[152:155], v[52:55], v[152:155]
  ds_read_b128 a[124:127], v4 offset:8960
  v_fma_f32 v45, v45, s36, v30
  v_mfma_f32_16x16x32_bf16 v[156:159], a[156:159], v[52:55], v[156:159]
  buffer_load_dwordx4 v2, s[20:23], s35 offen nt lds
  v_smfmac_f32_16x16x64_bf16 a[196:199], a[204:207], v[52:59], v7
  v_fma_f32 v46, v46, s36, v30
  v_mfma_f32_16x16x32_bf16 v[160:163], a[128:131], v[56:59], v[160:163]
  v_exp_f32 v41, v41
  v_mfma_f32_16x16x32_bf16 v[164:167], a[132:135], v[56:59], v[164:167]
  v_exp_f32 v33, v33
  v_mfma_f32_16x16x32_bf16 v[168:171], a[136:139], v[56:59], v[168:171]
  v_cvt_pk_bf16_f32 v40, v40, v41
  v_cvt_pk_bf16_f32 v38, v32, v33
  v_mfma_f32_16x16x32_bf16 v[172:175], a[140:143], v[56:59], v[172:175]
  v_exp_f32 v42, v42
  v_mfma_f32_16x16x32_bf16 v[176:179], a[144:147], v[56:59], v[176:179]
  v_exp_f32 v34, v34
  v_mfma_f32_16x16x32_bf16 v[180:183], a[148:151], v[56:59], v[180:183]
  v_exp_f32 v43, v43
  v_mfma_f32_16x16x32_bf16 v[184:187], a[152:155], v[56:59], v[184:187]
  v_exp_f32 v35, v35
  v_mfma_f32_16x16x32_bf16 v[188:191], a[156:159], v[56:59], v[188:191]
  s_waitcnt lgkmcnt(0)
  v_cvt_pk_bf16_f32 v41, v42, v43
  v_cvt_pk_bf16_f32 v39, v34, v35
  v_mfma_f32_16x16x32_bf16 v[52:55], a[96:99], a[32:35], v[18:21]
  v_exp_f32 v44, v44
  v_mfma_f32_16x16x32_bf16 v[52:55], a[100:103], a[36:39], v[52:55]
  v_exp_f32 v45, v45
  v_mfma_f32_16x16x32_bf16 v[52:55], a[104:107], a[40:43], v[52:55]
  v_cvt_pk_bf16_f32 v42, v44, v45
  v_fma_f32 v47, v47, s36, v30
  v_mfma_f32_16x16x32_bf16 v[52:55], a[108:111], a[44:47], v[52:55]
  v_exp_f32 v46, v46
  v_mfma_f32_16x16x32_bf16 v[48:51], a[112:115], a[32:35], v[18:21]
  v_exp_f32 v47, v47
  v_mfma_f32_16x16x32_bf16 v[48:51], a[116:119], a[36:39], v[48:51]
  buffer_load_dwordx4 v2, s[20:23], s35 offen offset:1024 nt lds
  v_mfma_f32_16x16x32_bf16 v[48:51], a[120:123], a[40:43], v[48:51]
  v_exp_f32 v52, v52
  v_mfma_f32_16x16x32_bf16 v[48:51], a[124:127], a[44:47], v[48:51]
  v_exp_f32 v53, v53
  v_mfma_f32_16x16x32_bf16 v[56:59], a[96:99], a[48:51], v[22:25]
  v_cvt_pk_bf16_f32 v43, v46, v47
  v_cvt_pk_bf16_f32 v52, v52, v53
  v_mfma_f32_16x16x32_bf16 v[56:59], a[100:103], a[52:55], v[56:59]
  v_exp_f32 v54, v54
  v_mfma_f32_16x16x32_bf16 v[56:59], a[104:107], a[56:59], v[56:59]
  v_exp_f32 v55, v55
  v_mfma_f32_16x16x32_bf16 v[56:59], a[108:111], a[60:63], v[56:59]
  v_cvt_pk_bf16_f32 v53, v54, v55
  v_mfma_f32_16x16x32_bf16 v[60:63], a[112:115], a[48:51], v[22:25]
  v_exp_f32 v48, v48
  v_mfma_f32_16x16x32_bf16 v[60:63], a[116:119], a[52:55], v[60:63]
  v_exp_f32 v56, v56
  v_mfma_f32_16x16x32_bf16 v[60:63], a[120:123], a[56:59], v[60:63]
  v_exp_f32 v57, v57
  v_mfma_f32_16x16x32_bf16 v[60:63], a[124:127], a[60:63], v[60:63]
  v_exp_f32 v49, v49
  v_mfma_f32_16x16x32_bf16 v[192:195], a[128:131], v[36:39], v[192:195]
  v_cvt_pk_bf16_f32 v56, v56, v57
  v_cvt_pk_bf16_f32 v54, v48, v49
  v_mfma_f32_16x16x32_bf16 v[196:199], a[132:135], v[36:39], v[196:199]
  v_exp_f32 v58, v58
  v_mfma_f32_16x16x32_bf16 v[200:203], a[136:139], v[36:39], v[200:203]
  v_exp_f32 v50, v50
  v_mfma_f32_16x16x32_bf16 v[204:207], a[140:143], v[36:39], v[204:207]
  v_exp_f32 v59, v59
  v_mfma_f32_16x16x32_bf16 v[208:211], a[144:147], v[36:39], v[208:211]
  v_exp_f32 v51, v51
  v_mfma_f32_16x16x32_bf16 v[212:215], a[148:151], v[36:39], v[212:215]
  buffer_load_dwordx4 v0, s[24:27], s35 offen offset:2048 nt lds
  v_mfma_f32_16x16x32_bf16 v[216:219], a[152:155], v[36:39], v[216:219]
  v_cvt_pk_bf16_f32 v57, v58, v59
  v_cvt_pk_bf16_f32 v55, v50, v51
  v_mfma_f32_16x16x32_bf16 v[220:223], a[156:159], v[36:39], v[220:223]
  v_exp_f32 v60, v60
  v_smfmac_f32_16x16x64_bf16 a[200:203], a[204:207], v[36:43], v7
  s_waitcnt vmcnt(5)
  s_barrier
  v_mfma_f32_16x16x32_bf16 v[224:227], a[128:131], v[40:43], v[224:227]
  ds_read_b64_tr_b16 a[128:129], v5 offset:2048
  ds_read_b64_tr_b16 a[130:131], v5 offset:10240
  v_mfma_f32_16x16x32_bf16 v[228:231], a[132:135], v[40:43], v[228:231]
  ds_read_b64_tr_b16 a[132:133], v6 offset:2048
  ds_read_b64_tr_b16 a[134:135], v6 offset:10240
  v_mfma_f32_16x16x32_bf16 v[232:235], a[136:139], v[40:43], v[232:235]
  ds_read_b64_tr_b16 a[136:137], v5 offset:2304
  ds_read_b64_tr_b16 a[138:139], v5 offset:10496
  v_mfma_f32_16x16x32_bf16 v[236:239], a[140:143], v[40:43], v[236:239]
  ds_read_b64_tr_b16 a[140:141], v6 offset:2304
  ds_read_b64_tr_b16 a[142:143], v6 offset:10496
  v_mfma_f32_16x16x32_bf16 v[240:243], a[144:147], v[40:43], v[240:243]
  ds_read_b64_tr_b16 a[144:145], v5 offset:2560
  ds_read_b64_tr_b16 a[146:147], v5 offset:10752
  v_mfma_f32_16x16x32_bf16 v[244:247], a[148:151], v[40:43], v[244:247]
  ds_read_b64_tr_b16 a[148:149], v6 offset:2560
  ds_read_b64_tr_b16 a[150:151], v6 offset:10752
  v_mfma_f32_16x16x32_bf16 v[248:251], a[152:155], v[40:43], v[248:251]
  ds_read_b64_tr_b16 a[152:153], v5 offset:2816
  ds_read_b64_tr_b16 a[154:155], v5 offset:11008
  v_mfma_f32_16x16x32_bf16 v[252:255], a[156:159], v[40:43], v[252:255]
  ds_read_b64_tr_b16 a[156:157], v6 offset:2816
  ds_read_b64_tr_b16 a[158:159], v6 offset:11008
  v_mfma_f32_16x16x32_bf16 v[36:39], a[96:99], a[64:67], v[26:29]
  v_exp_f32 v61, v61
  v_mfma_f32_16x16x32_bf16 v[36:39], a[100:103], a[68:71], v[36:39]
  v_exp_f32 v62, v62
  v_mfma_f32_16x16x32_bf16 v[36:39], a[104:107], a[72:75], v[36:39]
  v_exp_f32 v63, v63
  v_mfma_f32_16x16x32_bf16 v[36:39], a[108:111], a[76:79], v[36:39]
  v_cvt_pk_bf16_f32 v58, v60, v61
  v_cvt_pk_bf16_f32 v59, v62, v63
  v_mfma_f32_16x16x32_bf16 v[32:35], a[112:115], a[64:67], v[26:29]
  buffer_load_dwordx4 v1, s[24:27], s35 offen offset:3072 nt lds
  v_mfma_f32_16x16x32_bf16 v[32:35], a[116:119], a[68:71], v[32:35]
  v_accvgpr_read_b32 v0, a208
  v_accvgpr_read_b32 v1, a209
  v_mfma_f32_16x16x32_bf16 v[32:35], a[120:123], a[72:75], v[32:35]
  v_accvgpr_read_b32 v2, a210
  v_accvgpr_read_b32 v3, a211
  v_mfma_f32_16x16x32_bf16 v[32:35], a[124:127], a[76:79], v[32:35]
  v_exp_f32 v36, v36
  v_mfma_f32_16x16x32_bf16 v[40:43], a[96:99], a[80:83], 0
  ds_read_b128 a[96:99], v4 offset:16384
  v_accvgpr_read_b32 v8, a220
  v_mfma_f32_16x16x32_bf16 v[40:43], a[100:103], a[84:87], v[40:43]
  ds_read_b128 a[100:103], v4 offset:16640
  v_mfma_f32_16x16x32_bf16 v[40:43], a[104:107], a[88:91], v[40:43]
  ds_read_b128 a[104:107], v4 offset:16896
  v_mfma_f32_16x16x32_bf16 v[40:43], a[108:111], a[92:95], v[40:43]
  ds_read_b128 a[108:111], v4 offset:17152
  v_mfma_f32_16x16x32_bf16 v[44:47], a[112:115], a[80:83], 0
  ds_read_b128 a[112:115], v4 offset:24576
  v_mfma_f32_16x16x32_bf16 v[44:47], a[116:119], a[84:87], v[44:47]
  ds_read_b128 a[116:119], v4 offset:24832
  v_fma_f32 v40, v40, s36, v30
  v_mfma_f32_16x16x32_bf16 v[44:47], a[120:123], a[88:91], v[44:47]
  ds_read_b128 a[120:123], v4 offset:25088
  v_fma_f32 v41, v41, s36, v30
  v_mfma_f32_16x16x32_bf16 v[44:47], a[124:127], a[92:95], v[44:47]
  s_waitcnt lgkmcnt(7)
  ds_read_b128 a[124:127], v4 offset:25344
  v_add_u32 v4, 0xfffe0000, v4
  v_mfma_f32_16x16x32_bf16 v[128:131], a[128:131], v[52:55], v[128:131]
  v_exp_f32 v37, v37
  v_mfma_f32_16x16x32_bf16 v[132:135], a[132:135], v[52:55], v[132:135]
  v_cvt_pk_bf16_f32 v36, v36, v37
  v_fma_f32 v42, v42, s36, v30
  v_mfma_f32_16x16x32_bf16 v[136:139], a[136:139], v[52:55], v[136:139]
  v_exp_f32 v38, v38
  v_mfma_f32_16x16x32_bf16 v[140:143], a[140:143], v[52:55], v[140:143]
  v_exp_f32 v39, v39
  v_mfma_f32_16x16x32_bf16 v[144:147], a[144:147], v[52:55], v[144:147]
  v_cvt_pk_bf16_f32 v37, v38, v39
  v_fma_f32 v43, v43, s36, v30
  v_mfma_f32_16x16x32_bf16 v[148:151], a[148:151], v[52:55], v[148:151]
  v_exp_f32 v40, v40
  v_mfma_f32_16x16x32_bf16 v[152:155], a[152:155], v[52:55], v[152:155]
  v_exp_f32 v32, v32
  v_mfma_f32_16x16x32_bf16 v[156:159], a[156:159], v[52:55], v[156:159]
  v_exp_f32 v41, v41
  v_smfmac_f32_16x16x64_bf16 a[196:199], a[204:207], v[52:59], v7
  v_cvt_pk_bf16_f32 v40, v40, v41
  v_mfma_f32_16x16x32_bf16 v[160:163], a[128:131], v[56:59], v[160:163]
  v_exp_f32 v33, v33
  v_mfma_f32_16x16x32_bf16 v[164:167], a[132:135], v[56:59], v[164:167]
  v_cvt_pk_bf16_f32 v38, v32, v33
  v_fma_f32 v44, v44, s36, v30
  v_mfma_f32_16x16x32_bf16 v[168:171], a[136:139], v[56:59], v[168:171]
  v_exp_f32 v42, v42
  v_mfma_f32_16x16x32_bf16 v[172:175], a[140:143], v[56:59], v[172:175]
  v_exp_f32 v34, v34
  v_mfma_f32_16x16x32_bf16 v[176:179], a[144:147], v[56:59], v[176:179]
  v_exp_f32 v43, v43
  v_mfma_f32_16x16x32_bf16 v[180:183], a[148:151], v[56:59], v[180:183]
  v_exp_f32 v35, v35
  v_mfma_f32_16x16x32_bf16 v[184:187], a[152:155], v[56:59], v[184:187]
  v_cvt_pk_bf16_f32 v41, v42, v43
  v_cvt_pk_bf16_f32 v39, v34, v35
  v_mfma_f32_16x16x32_bf16 v[188:191], a[156:159], v[56:59], v[188:191]
  s_waitcnt lgkmcnt(0)
  v_fma_f32 v45, v45, s36, v30
  v_fma_f32 v46, v46, s36, v30
  v_mfma_f32_16x16x32_bf16 v[52:55], a[96:99], a[64:67], v[26:29]
  v_exp_f32 v44, v44
  v_mfma_f32_16x16x32_bf16 v[52:55], a[100:103], a[68:71], v[52:55]
  v_exp_f32 v45, v45
  v_mfma_f32_16x16x32_bf16 v[52:55], a[104:107], a[72:75], v[52:55]
  v_cvt_pk_bf16_f32 v42, v44, v45
  v_fma_f32 v47, v47, s36, v30
  v_mfma_f32_16x16x32_bf16 v[52:55], a[108:111], a[76:79], v[52:55]
  v_exp_f32 v46, v46
  v_mfma_f32_16x16x32_bf16 v[48:51], a[112:115], a[64:67], v[26:29]
  v_exp_f32 v47, v47
  v_mfma_f32_16x16x32_bf16 v[48:51], a[116:119], a[68:71], v[48:51]
  v_exp_f32 v52, v52
  v_mfma_f32_16x16x32_bf16 v[48:51], a[120:123], a[72:75], v[48:51]
  v_exp_f32 v53, v53
  v_mfma_f32_16x16x32_bf16 v[48:51], a[124:127], a[76:79], v[48:51]
  v_cvt_pk_bf16_f32 v43, v46, v47
  v_cvt_pk_bf16_f32 v52, v52, v53
  v_mfma_f32_16x16x32_bf16 v[56:59], a[96:99], a[80:83], 0
  v_exp_f32 v54, v54
  v_mfma_f32_16x16x32_bf16 v[56:59], a[100:103], a[84:87], v[56:59]
  ds_read_b128 a[96:99], v4 offset:0
  ds_read_b128 a[100:103], v4 offset:256
  v_mfma_f32_16x16x32_bf16 v[56:59], a[104:107], a[88:91], v[56:59]
  v_exp_f32 v55, v55
  v_mfma_f32_16x16x32_bf16 v[56:59], a[108:111], a[92:95], v[56:59]
  ds_read_b128 a[104:107], v4 offset:512
  ds_read_b128 a[108:111], v4 offset:768
  v_mfma_f32_16x16x32_bf16 v[60:63], a[112:115], a[80:83], 0
  ds_read_b128 a[112:115], v4 offset:8192
  v_cvt_pk_bf16_f32 v53, v54, v55
  v_mfma_f32_16x16x32_bf16 v[60:63], a[116:119], a[84:87], v[60:63]
  ds_read_b128 a[116:119], v4 offset:8448
  v_fma_f32 v56, v56, s36, v30
  v_mfma_f32_16x16x32_bf16 v[60:63], a[120:123], a[88:91], v[60:63]
  ds_read_b128 a[120:123], v4 offset:8704
  v_fma_f32 v57, v57, s36, v30
  v_mfma_f32_16x16x32_bf16 v[60:63], a[124:127], a[92:95], v[60:63]
  ds_read_b128 a[124:127], v4 offset:8960
  v_fma_f32 v58, v58, s36, v30
  v_mfma_f32_16x16x32_bf16 v[192:195], a[128:131], v[36:39], v[192:195]
  v_exp_f32 v56, v56
  v_mfma_f32_16x16x32_bf16 v[196:199], a[132:135], v[36:39], v[196:199]
  v_exp_f32 v48, v48
  v_mfma_f32_16x16x32_bf16 v[200:203], a[136:139], v[36:39], v[200:203]
  v_exp_f32 v57, v57
  v_mfma_f32_16x16x32_bf16 v[204:207], a[140:143], v[36:39], v[204:207]
  v_exp_f32 v49, v49
  v_mfma_f32_16x16x32_bf16 v[208:211], a[144:147], v[36:39], v[208:211]
  v_cvt_pk_bf16_f32 v56, v56, v57
  v_cvt_pk_bf16_f32 v54, v48, v49
  v_mfma_f32_16x16x32_bf16 v[212:215], a[148:151], v[36:39], v[212:215]
  v_fma_f32 v59, v59, s36, v30
  v_fma_f32 v60, v60, s36, v30
  v_mfma_f32_16x16x32_bf16 v[216:219], a[152:155], v[36:39], v[216:219]
  v_exp_f32 v58, v58
  v_mfma_f32_16x16x32_bf16 v[220:223], a[156:159], v[36:39], v[220:223]
  v_exp_f32 v50, v50
  v_smfmac_f32_16x16x64_bf16 a[200:203], a[204:207], v[36:43], v7
  v_fma_f32 v61, v61, s36, v30
  v_mfma_f32_16x16x32_bf16 v[224:227], a[128:131], v[40:43], v[224:227]
  ds_read_b64_tr_b16 a[128:129], v5 offset:18432
  ds_read_b64_tr_b16 a[130:131], v5 offset:26624
  v_mfma_f32_16x16x32_bf16 v[228:231], a[132:135], v[40:43], v[228:231]
  ds_read_b64_tr_b16 a[132:133], v6 offset:18432
  ds_read_b64_tr_b16 a[134:135], v6 offset:26624
  v_mfma_f32_16x16x32_bf16 v[232:235], a[136:139], v[40:43], v[232:235]
  ds_read_b64_tr_b16 a[136:137], v5 offset:18688
  ds_read_b64_tr_b16 a[138:139], v5 offset:26880
  v_mfma_f32_16x16x32_bf16 v[236:239], a[140:143], v[40:43], v[236:239]
  ds_read_b64_tr_b16 a[140:141], v6 offset:18688
  ds_read_b64_tr_b16 a[142:143], v6 offset:26880
  v_mfma_f32_16x16x32_bf16 v[240:243], a[144:147], v[40:43], v[240:243]
  ds_read_b64_tr_b16 a[144:145], v5 offset:18944
  ds_read_b64_tr_b16 a[146:147], v5 offset:27136
  v_mfma_f32_16x16x32_bf16 v[244:247], a[148:151], v[40:43], v[244:247]
  ds_read_b64_tr_b16 a[148:149], v6 offset:18944
  ds_read_b64_tr_b16 a[150:151], v6 offset:27136
  v_mfma_f32_16x16x32_bf16 v[248:251], a[152:155], v[40:43], v[248:251]
  ds_read_b64_tr_b16 a[152:153], v5 offset:19200
  ds_read_b64_tr_b16 a[154:155], v5 offset:27392
  v_mfma_f32_16x16x32_bf16 v[252:255], a[156:159], v[40:43], v[252:255]
  s_waitcnt lgkmcnt(14)
  ds_read_b64_tr_b16 a[156:157], v6 offset:19200
  ds_read_b64_tr_b16 a[158:159], v6 offset:27392
  v_mfma_f32_16x16x32_bf16 v[36:39], a[96:99], a[64:67], v[26:29]
  v_exp_f32 v59, v59
  v_mfma_f32_16x16x32_bf16 v[36:39], a[100:103], a[68:71], v[36:39]
  v_exp_f32 v51, v51
  v_mfma_f32_16x16x32_bf16 v[36:39], a[104:107], a[72:75], v[36:39]
  v_cvt_pk_bf16_f32 v57, v58, v59
  v_cvt_pk_bf16_f32 v55, v50, v51
  v_mfma_f32_16x16x32_bf16 v[36:39], a[108:111], a[76:79], v[36:39]
  v_exp_f32 v60, v60
  v_mfma_f32_16x16x32_bf16 v[32:35], a[112:115], a[64:67], v[26:29]
  v_exp_f32 v61, v61
  v_mfma_f32_16x16x32_bf16 v[32:35], a[116:119], a[68:71], v[32:35]
  v_cvt_pk_bf16_f32 v58, v60, v61
  v_fma_f32 v62, v62, s36, v30
  v_mfma_f32_16x16x32_bf16 v[32:35], a[120:123], a[72:75], v[32:35]
  s_waitcnt vmcnt(2)
  s_barrier
  v_mfma_f32_16x16x32_bf16 v[32:35], a[124:127], a[76:79], v[32:35]
  ds_read_b128 a[160:163], v4 offset:16384
  v_fma_f32 v63, v63, s36, v30
  v_mfma_f32_16x16x32_bf16 v[40:43], a[96:99], a[80:83], 0
  v_exp_f32 v62, v62
  v_mfma_f32_16x16x32_bf16 v[40:43], a[100:103], a[84:87], v[40:43]
  v_exp_f32 v63, v63
  v_mfma_f32_16x16x32_bf16 v[40:43], a[104:107], a[88:91], v[40:43]
  ds_read_b128 a[164:167], v4 offset:16640
  v_cvt_pk_bf16_f32 v59, v62, v63
  v_mfma_f32_16x16x32_bf16 v[40:43], a[108:111], a[92:95], v[40:43]
  ds_read_b128 a[168:171], v4 offset:16896
  ds_read_b128 a[172:175], v4 offset:17152
  v_mfma_f32_16x16x32_bf16 v[44:47], a[112:115], a[80:83], 0
  v_add_u32 v5, 0xfffe0000, v5
  v_add_u32 v6, 0xfffe0000, v6
  v_mfma_f32_16x16x32_bf16 v[44:47], a[116:119], a[84:87], v[44:47]
  ds_read_b128 a[176:179], v4 offset:24576
  ds_read_b128 a[180:183], v4 offset:24832
  v_mfma_f32_16x16x32_bf16 v[44:47], a[120:123], a[88:91], v[44:47]
  ds_read_b128 a[184:187], v4 offset:25088
  ds_read_b128 a[188:191], v4 offset:25344
  v_mfma_f32_16x16x32_bf16 v[44:47], a[124:127], a[92:95], v[44:47]
  s_waitcnt lgkmcnt(8)
  v_exp_f32 v36, v36
  v_mfma_f32_16x16x32_bf16 v[192:195], a[128:131], v[52:55], v[192:195]
  v_exp_f32 v37, v37
  v_mfma_f32_16x16x32_bf16 v[196:199], a[132:135], v[52:55], v[196:199]
  v_cvt_pk_bf16_f32 v36, v36, v37
  v_fma_f32 v40, v40, s36, v30
  v_mfma_f32_16x16x32_bf16 v[200:203], a[136:139], v[52:55], v[200:203]
  v_exp_f32 v38, v38
  v_mfma_f32_16x16x32_bf16 v[204:207], a[140:143], v[52:55], v[204:207]
  v_exp_f32 v39, v39
  v_mfma_f32_16x16x32_bf16 v[208:211], a[144:147], v[52:55], v[208:211]
  v_cvt_pk_bf16_f32 v37, v38, v39
  v_fma_f32 v41, v41, s36, v30
  v_mfma_f32_16x16x32_bf16 v[212:215], a[148:151], v[52:55], v[212:215]
  v_exp_f32 v40, v40
  v_mfma_f32_16x16x32_bf16 v[216:219], a[152:155], v[52:55], v[216:219]
  v_exp_f32 v32, v32
  v_mfma_f32_16x16x32_bf16 v[220:223], a[156:159], v[52:55], v[220:223]
  v_exp_f32 v41, v41
  v_smfmac_f32_16x16x64_bf16 a[200:203], a[204:207], v[52:59], v7
  v_cvt_pk_bf16_f32 v40, v40, v41
  v_mfma_f32_16x16x32_bf16 v[224:227], a[128:131], v[56:59], v[224:227]
  ds_read_b64_tr_b16 a[128:129], v5 offset:2048
  ds_read_b64_tr_b16 a[130:131], v5 offset:10240
  v_mfma_f32_16x16x32_bf16 v[228:231], a[132:135], v[56:59], v[228:231]
  ds_read_b64_tr_b16 a[132:133], v6 offset:2048
  ds_read_b64_tr_b16 a[134:135], v6 offset:10240
  v_mfma_f32_16x16x32_bf16 v[232:235], a[136:139], v[56:59], v[232:235]
  ds_read_b64_tr_b16 a[136:137], v5 offset:2304
  ds_read_b64_tr_b16 a[138:139], v5 offset:10496
  v_mfma_f32_16x16x32_bf16 v[236:239], a[140:143], v[56:59], v[236:239]
  ds_read_b64_tr_b16 a[140:141], v6 offset:2304
  ds_read_b64_tr_b16 a[142:143], v6 offset:10496
  v_mfma_f32_16x16x32_bf16 v[240:243], a[144:147], v[56:59], v[240:243]
  ds_read_b64_tr_b16 a[144:145], v5 offset:2560
  ds_read_b64_tr_b16 a[146:147], v5 offset:10752
  v_mfma_f32_16x16x32_bf16 v[244:247], a[148:151], v[56:59], v[244:247]
  ds_read_b64_tr_b16 a[148:149], v6 offset:2560
  ds_read_b64_tr_b16 a[150:151], v6 offset:10752
  v_mfma_f32_16x16x32_bf16 v[248:251], a[152:155], v[56:59], v[248:251]
  v_exp_f32 v33, v33
  v_mfma_f32_16x16x32_bf16 v[252:255], a[156:159], v[56:59], v[252:255]
  s_waitcnt lgkmcnt(12)
  ds_read_b64_tr_b16 a[152:153], v5 offset:2816
  ds_read_b64_tr_b16 a[154:155], v5 offset:11008
  v_mfma_f32_16x16x32_bf16 v[52:55], a[160:163], a[64:67], v[26:29]
  ds_read_b64_tr_b16 a[156:157], v6 offset:2816
  v_cvt_pk_bf16_f32 v38, v32, v33
  v_mfma_f32_16x16x32_bf16 v[52:55], a[164:167], a[68:71], v[52:55]
  ds_read_b64_tr_b16 a[158:159], v6 offset:11008
  v_fma_f32 v42, v42, s36, v30
  v_mfma_f32_16x16x32_bf16 v[52:55], a[168:171], a[72:75], v[52:55]
  v_fma_f32 v43, v43, s36, v30
  v_fma_f32 v44, v44, s36, v30
  v_mfma_f32_16x16x32_bf16 v[52:55], a[172:175], a[76:79], v[52:55]
  v_exp_f32 v42, v42
  v_mfma_f32_16x16x32_bf16 v[48:51], a[176:179], a[64:67], v[26:29]
  v_exp_f32 v34, v34
  v_mfma_f32_16x16x32_bf16 v[48:51], a[180:183], a[68:71], v[48:51]
  v_exp_f32 v43, v43
  v_mfma_f32_16x16x32_bf16 v[48:51], a[184:187], a[72:75], v[48:51]
  v_exp_f32 v35, v35
  v_mfma_f32_16x16x32_bf16 v[48:51], a[188:191], a[76:79], v[48:51]
  v_cvt_pk_bf16_f32 v41, v42, v43
  v_cvt_pk_bf16_f32 v39, v34, v35
  v_mfma_f32_16x16x32_bf16 v[56:59], a[160:163], a[80:83], 0
  s_waitcnt vmcnt(0)
  s_barrier
  v_mfma_f32_16x16x32_bf16 v[56:59], a[164:167], a[84:87], v[56:59]
  v_fma_f32 v45, v45, s36, v30
  v_fma_f32 v46, v46, s36, v30
  v_mfma_f32_16x16x32_bf16 v[56:59], a[168:171], a[88:91], v[56:59]
  v_exp_f32 v44, v44
  v_mfma_f32_16x16x32_bf16 v[56:59], a[172:175], a[92:95], v[56:59]
  v_exp_f32 v45, v45
  v_mfma_f32_16x16x32_bf16 v[60:63], a[176:179], a[80:83], 0
  v_cvt_pk_bf16_f32 v42, v44, v45
  v_fma_f32 v47, v47, s36, v30
  v_mfma_f32_16x16x32_bf16 v[60:63], a[180:183], a[84:87], v[60:63]
  v_exp_f32 v46, v46
  v_mfma_f32_16x16x32_bf16 v[60:63], a[184:187], a[88:91], v[60:63]
  v_exp_f32 v47, v47
  v_mfma_f32_16x16x32_bf16 v[60:63], a[188:191], a[92:95], v[60:63]
  s_waitcnt lgkmcnt(0)
  ds_read_b64_tr_b16 a[224:225], v5 offset:18432
  v_cvt_pk_bf16_f32 v43, v46, v47
  v_mfma_f32_16x16x32_bf16 v[192:195], a[128:131], v[36:39], v[192:195]
  v_exp_f32 v52, v52
  v_mfma_f32_16x16x32_bf16 v[196:199], a[132:135], v[36:39], v[196:199]
  v_exp_f32 v53, v53
  v_mfma_f32_16x16x32_bf16 v[200:203], a[136:139], v[36:39], v[200:203]
  ds_read_b64_tr_b16 a[226:227], v5 offset:26624
  v_cvt_pk_bf16_f32 v52, v52, v53
  v_mfma_f32_16x16x32_bf16 v[204:207], a[140:143], v[36:39], v[204:207]
  v_exp_f32 v54, v54
  v_mfma_f32_16x16x32_bf16 v[208:211], a[144:147], v[36:39], v[208:211]
  ds_read_b64_tr_b16 a[228:229], v6 offset:18432
  ds_read_b64_tr_b16 a[230:231], v6 offset:26624
  v_mfma_f32_16x16x32_bf16 v[212:215], a[148:151], v[36:39], v[212:215]
  v_exp_f32 v55, v55
  v_mfma_f32_16x16x32_bf16 v[216:219], a[152:155], v[36:39], v[216:219]
  ds_read_b64_tr_b16 a[232:233], v5 offset:18688
  ds_read_b64_tr_b16 a[234:235], v5 offset:26880
  v_mfma_f32_16x16x32_bf16 v[220:223], a[156:159], v[36:39], v[220:223]
  v_cvt_pk_bf16_f32 v53, v54, v55
  v_fma_f32 v56, v56, s36, v30
  v_smfmac_f32_16x16x64_bf16 a[200:203], a[204:207], v[36:43], v7
  ds_read_b64_tr_b16 a[236:237], v6 offset:18688
  v_mfma_f32_16x16x32_bf16 v[224:227], a[128:131], v[40:43], v[224:227]
  ds_read_b64_tr_b16 a[238:239], v6 offset:26880
  v_fma_f32 v57, v57, s36, v30
  v_mfma_f32_16x16x32_bf16 v[228:231], a[132:135], v[40:43], v[228:231]
  ds_read_b64_tr_b16 a[240:241], v5 offset:18944
  ds_read_b64_tr_b16 a[242:243], v5 offset:27136
  v_mfma_f32_16x16x32_bf16 v[232:235], a[136:139], v[40:43], v[232:235]
  v_exp_f32 v56, v56
  v_mfma_f32_16x16x32_bf16 v[236:239], a[140:143], v[40:43], v[236:239]
  v_exp_f32 v48, v48
  v_mfma_f32_16x16x32_bf16 v[240:243], a[144:147], v[40:43], v[240:243]
  ds_read_b64_tr_b16 a[244:245], v6 offset:18944
  ds_read_b64_tr_b16 a[246:247], v6 offset:27136
  v_mfma_f32_16x16x32_bf16 v[244:247], a[148:151], v[40:43], v[244:247]
  v_exp_f32 v57, v57
  v_mfma_f32_16x16x32_bf16 v[248:251], a[152:155], v[40:43], v[248:251]
  v_exp_f32 v49, v49
  v_mfma_f32_16x16x32_bf16 v[252:255], a[156:159], v[40:43], v[252:255]
  ds_read_b64_tr_b16 a[248:249], v5 offset:19200
  ds_read_b64_tr_b16 a[250:251], v5 offset:27392
  v_mfma_f32_16x16x32_bf16 v[36:39], a[160:163], a[32:35], v[18:21]
  v_cvt_pk_bf16_f32 v56, v56, v57
  v_cvt_pk_bf16_f32 v54, v48, v49
  v_mfma_f32_16x16x32_bf16 v[36:39], a[164:167], a[36:39], v[36:39]
  ds_read_b64_tr_b16 a[252:253], v6 offset:19200
  ds_read_b64_tr_b16 a[254:255], v6 offset:27392
  v_mfma_f32_16x16x32_bf16 v[36:39], a[168:171], a[40:43], v[36:39]
  v_fma_f32 v58, v58, s36, v30
  v_fma_f32 v59, v59, s36, v30
  v_mfma_f32_16x16x32_bf16 v[36:39], a[172:175], a[44:47], v[36:39]
  v_exp_f32 v58, v58
  v_mfma_f32_16x16x32_bf16 v[32:35], a[176:179], a[32:35], v[18:21]
  v_exp_f32 v50, v50
  v_mfma_f32_16x16x32_bf16 v[32:35], a[180:183], a[36:39], v[32:35]
  v_exp_f32 v59, v59
  v_mfma_f32_16x16x32_bf16 v[32:35], a[184:187], a[40:43], v[32:35]
  v_exp_f32 v51, v51
  v_mfma_f32_16x16x32_bf16 v[32:35], a[188:191], a[44:47], v[32:35]
  v_cvt_pk_bf16_f32 v57, v58, v59
  v_cvt_pk_bf16_f32 v55, v50, v51
  v_mfma_f32_16x16x32_bf16 v[40:43], a[160:163], a[48:51], v[22:25]
  v_fma_f32 v60, v60, s36, v30
  v_fma_f32 v61, v61, s36, v30
  v_mfma_f32_16x16x32_bf16 v[40:43], a[164:167], a[52:55], v[40:43]
L_isl5:
  s_cbranch_execz L_retB
  v_exp_f32 v60, v60
  v_mfma_f32_16x16x32_bf16 v[40:43], a[168:171], a[56:59], v[40:43]
  v_exp_f32 v61, v61
  v_mfma_f32_16x16x32_bf16 v[40:43], a[172:175], a[60:63], v[40:43]
  v_cvt_pk_bf16_f32 v58, v60, v61
  v_fma_f32 v62, v62, s36, v30
  v_mfma_f32_16x16x32_bf16 v[44:47], a[176:179], a[48:51], v[22:25]
  v_fma_f32 v63, v63, s36, v30
  v_add_u32 v4, 0x20000, v4
  v_mfma_f32_16x16x32_bf16 v[44:47], a[180:183], a[52:55], v[44:47]
  v_exp_f32 v62, v62
  v_mfma_f32_16x16x32_bf16 v[44:47], a[184:187], a[56:59], v[44:47]
  v_exp_f32 v63, v63
  v_mfma_f32_16x16x32_bf16 v[44:47], a[188:191], a[60:63], v[44:47]
  s_waitcnt lgkmcnt(0)
  v_cvt_pk_bf16_f32 v59, v62, v63
  v_add_u32 v5, 0x20000, v5
  v_mfma_f32_16x16x32_bf16 v[192:195], a[224:227], v[52:55], v[192:195]
  s_xor_b32 s39, s34, 65536
  v_exp_f32 v36, v36
  v_mfma_f32_16x16x32_bf16 v[196:199], a[228:231], v[52:55], v[196:199]
  v_exp_f32 v37, v37
  v_mfma_f32_16x16x32_bf16 v[200:203], a[232:235], v[52:55], v[200:203]
  v_cvt_pk_bf16_f32 v36, v36, v37
  v_add_u32 v6, 0x20000, v6
  v_mfma_f32_16x16x32_bf16 v[204:207], a[236:239], v[52:55], v[204:207]
  v_exp_f32 v38, v38
  v_mfma_f32_16x16x32_bf16 v[208:211], a[240:243], v[52:55], v[208:211]
  v_exp_f32 v39, v39
  v_mfma_f32_16x16x32_bf16 v[212:215], a[244:247], v[52:55], v[212:215]
  v_cvt_pk_bf16_f32 v37, v38, v39
  v_mfma_f32_16x16x32_bf16 v[216:219], a[248:251], v[52:55], v[216:219]
  v_exp_f32 v40, v40
  v_mfma_f32_16x16x32_bf16 v[220:223], a[252:255], v[52:55], v[220:223]
  v_exp_f32 v32, v32
  v_smfmac_f32_16x16x64_bf16 a[200:203], a[204:207], v[52:59], v7
  v_mfma_f32_16x16x32_bf16 v[224:227], a[224:227], v[56:59], v[224:227]
  s_xor_b32 s40, s34, 81920
  v_exp_f32 v41, v41
  v_mfma_f32_16x16x32_bf16 v[228:231], a[228:231], v[56:59], v[228:231]
  v_accvgpr_read_b32 v26, a200
  v_accvgpr_read_b32 v27, a201
  v_mfma_f32_16x16x32_bf16 v[232:235], a[232:235], v[56:59], v[232:235]
  v_add_f32 v26, v26, v27
  v_cmp_nge_f32 s[56:57], s37, v26
  v_mfma_f32_16x16x32_bf16 v[236:239], a[236:239], v[56:59], v[236:239]
  v_rcp_f32 v26, v26
  v_mfma_f32_16x16x32_bf16 v[240:243], a[240:243], v[56:59], v[240:243]
  v_mul_f32 v192, v192, v26
  v_mul_f32 v193, v193, v26
  v_mfma_f32_16x16x32_bf16 v[244:247], a[244:247], v[56:59], v[244:247]
  v_mul_f32 v194, v194, v26
  v_mul_f32 v195, v195, v26
  v_mfma_f32_16x16x32_bf16 v[248:251], a[248:251], v[56:59], v[248:251]
  v_mul_f32 v196, v196, v26
  v_mul_f32 v197, v197, v26
  v_mfma_f32_16x16x32_bf16 v[252:255], a[252:255], v[56:59], v[252:255]
  v_mul_f32 v198, v198, v26
  v_mul_f32 v199, v199, v26
  v_mfma_f32_16x16x32_bf16 v[52:55], a[96:99], a[32:35], v[18:21]
  v_cvt_pk_bf16_f32 v192, v192, v193
  v_cvt_pk_bf16_f32 v193, v194, v195
  v_mfma_f32_16x16x32_bf16 v[52:55], a[100:103], a[36:39], v[52:55]
  v_cvt_pk_bf16_f32 v194, v196, v197
  v_cvt_pk_bf16_f32 v195, v198, v199
  v_mfma_f32_16x16x32_bf16 v[52:55], a[104:107], a[40:43], v[52:55]
  v_permlane16_swap_b32 v192, v194
  v_permlane16_swap_b32 v193, v195
  v_mfma_f32_16x16x32_bf16 v[52:55], a[108:111], a[44:47], v[52:55]
  v_exp_f32 v33, v33
  v_mfma_f32_16x16x32_bf16 v[48:51], a[112:115], a[32:35], v[18:21]
  v_mul_f32 v200, v200, v26
  v_cvt_pk_bf16_f32 v40, v40, v41
  v_mfma_f32_16x16x32_bf16 v[48:51], a[116:119], a[36:39], v[48:51]
  v_mul_f32 v201, v201, v26
  v_cvt_pk_bf16_f32 v38, v32, v33
  v_mfma_f32_16x16x32_bf16 v[48:51], a[120:123], a[40:43], v[48:51]
  v_mul_f32 v202, v202, v26
  v_mul_f32 v203, v203, v26
  v_mfma_f32_16x16x32_bf16 v[48:51], a[124:127], a[44:47], v[48:51]
  v_mul_f32 v204, v204, v26
  v_mul_f32 v205, v205, v26
  v_mfma_f32_16x16x32_bf16 v[56:59], a[96:99], a[48:51], v[22:25]
  v_exp_f32 v42, v42
  v_mfma_f32_16x16x32_bf16 v[56:59], a[100:103], a[52:55], v[56:59]
  v_exp_f32 v34, v34
  v_mfma_f32_16x16x32_bf16 v[56:59], a[104:107], a[56:59], v[56:59]
  v_exp_f32 v43, v43
  v_mfma_f32_16x16x32_bf16 v[56:59], a[108:111], a[60:63], v[56:59]
  v_mul_f32 v206, v206, v26
  v_mul_f32 v207, v207, v26
  v_mfma_f32_16x16x32_bf16 v[60:63], a[112:115], a[48:51], v[22:25]
  v_exp_f32 v35, v35
  v_mfma_f32_16x16x32_bf16 v[60:63], a[116:119], a[52:55], v[60:63]
  v_cvt_pk_bf16_f32 v41, v42, v43
  v_cvt_pk_bf16_f32 v200, v200, v201
  v_mfma_f32_16x16x32_bf16 v[60:63], a[120:123], a[56:59], v[60:63]
  v_cvt_pk_bf16_f32 v39, v34, v35
  v_cvt_pk_bf16_f32 v201, v202, v203
  v_mfma_f32_16x16x32_bf16 v[60:63], a[124:127], a[60:63], v[60:63]
  v_cvt_pk_bf16_f32 v202, v204, v205
  v_cvt_pk_bf16_f32 v203, v206, v207
  v_mfma_f32_16x16x32_bf16 v[128:131], a[224:227], v[36:39], v[128:131]
  v_exp_f32 v44, v44
  v_mfma_f32_16x16x32_bf16 v[132:135], a[228:231], v[36:39], v[132:135]
  v_exp_f32 v45, v45
  v_mfma_f32_16x16x32_bf16 v[136:139], a[232:235], v[36:39], v[136:139]
  v_permlane16_swap_b32 v200, v202
  v_permlane16_swap_b32 v201, v203
  v_cvt_pk_bf16_f32 v42, v44, v45
  v_mfma_f32_16x16x32_bf16 v[140:143], a[236:239], v[36:39], v[140:143]
  buffer_store_dwordx4 v[192:195], v8, s[28:31], s39 offen sc1
  v_mfma_f32_16x16x32_bf16 v[144:147], a[240:243], v[36:39], v[144:147]
  buffer_store_dwordx4 v[200:203], v8, s[28:31], s39 offen offset:64 sc1
  v_mul_f32 v208, v208, v26
  v_mul_f32 v209, v209, v26
  v_exp_f32 v46, v46
  v_mfma_f32_16x16x32_bf16 v[148:151], a[244:247], v[36:39], v[148:151]
  v_mul_f32 v210, v210, v26
  v_exp_f32 v47, v47
  v_mfma_f32_16x16x32_bf16 v[152:155], a[248:251], v[36:39], v[152:155]
  v_mul_f32 v211, v211, v26
  v_mul_f32 v212, v212, v26
  v_cvt_pk_bf16_f32 v43, v46, v47
  v_mfma_f32_16x16x32_bf16 v[156:159], a[252:255], v[36:39], v[156:159]
  ds_read_b128 a[64:67], v4 offset:16384
  ds_read_b128 a[68:71], v4 offset:16640
  ds_read_b128 a[72:75], v4 offset:16896
  ds_read_b128 a[76:79], v4 offset:17152
  v_mul_f32 v213, v213, v26
  v_mul_f32 v214, v214, v26
  v_smfmac_f32_16x16x64_bf16 a[196:199], a[204:207], v[36:43], v7
  v_mul_f32 v215, v215, v26
  v_mfma_f32_16x16x32_bf16 v[160:163], a[224:227], v[40:43], v[160:163]
  v_cvt_pk_bf16_f32 v208, v208, v209
  v_cvt_pk_bf16_f32 v209, v210, v211
  v_mfma_f32_16x16x32_bf16 v[164:167], a[228:231], v[40:43], v[164:167]
  v_cvt_pk_bf16_f32 v210, v212, v213
  v_cvt_pk_bf16_f32 v211, v214, v215
  v_mfma_f32_16x16x32_bf16 v[168:171], a[232:235], v[40:43], v[168:171]
  ds_read_b128 a[80:83], v4 offset:24576
  ds_read_b128 a[84:87], v4 offset:24832
  ds_read_b128 a[88:91], v4 offset:25088
  ds_read_b128 a[92:95], v4 offset:25344
  v_mfma_f32_16x16x32_bf16 v[172:175], a[236:239], v[40:43], v[172:175]
  v_permlane16_swap_b32 v208, v210
  v_permlane16_swap_b32 v209, v211
  v_mfma_f32_16x16x32_bf16 v[176:179], a[240:243], v[40:43], v[176:179]
  v_mul_f32 v216, v216, v26
  v_mul_f32 v217, v217, v26
  v_mfma_f32_16x16x32_bf16 v[180:183], a[244:247], v[40:43], v[180:183]
  v_accvgpr_read_b32 v30, a202
  v_mul_f32 v218, v218, v26
  v_mfma_f32_16x16x32_bf16 v[184:187], a[248:251], v[40:43], v[184:187]
  v_accvgpr_read_b32 v31, a203
  v_mul_f32 v219, v219, v26
  v_mfma_f32_16x16x32_bf16 v[188:191], a[252:255], v[40:43], v[188:191]
  s_waitcnt lgkmcnt(7)
  v_add_f32 v30, v30, v31
  v_mul_f32 v220, v220, v26
  v_mfma_f32_16x16x32_bf16 v[36:39], a[64:67], a[32:35], v[18:21]
  s_waitcnt lgkmcnt(4)
  v_cmp_nge_f32 s[58:59], s37, v30
  v_exp_f32 v52, v52
  v_mul_f32 v221, v221, v26
  v_mfma_f32_16x16x32_bf16 v[36:39], a[68:71], a[36:39], v[36:39]
  v_rcp_f32 v30, v30
  v_mul_f32 v222, v222, v26
  v_exp_f32 v53, v53
  v_mul_f32 v223, v223, v26
  v_mfma_f32_16x16x32_bf16 v[36:39], a[72:75], a[40:43], v[36:39]
  v_mul_f32 v224, v224, v30
  v_mul_f32 v225, v225, v30
  v_cvt_pk_bf16_f32 v52, v52, v53
  v_mul_f32 v226, v226, v30
  v_cvt_pk_bf16_f32 v216, v216, v217
  v_mfma_f32_16x16x32_bf16 v[36:39], a[76:79], a[44:47], v[36:39]
  s_waitcnt lgkmcnt(3)
  v_mul_f32 v227, v227, v30
  v_cvt_pk_bf16_f32 v217, v218, v219
  v_mul_f32 v228, v228, v30
  v_cvt_pk_bf16_f32 v218, v220, v221
  v_mfma_f32_16x16x32_bf16 v[32:35], a[80:83], a[32:35], v[18:21]
  s_waitcnt lgkmcnt(0)
  v_mul_f32 v229, v229, v30
  v_cvt_pk_bf16_f32 v219, v222, v223
  v_exp_f32 v54, v54
  v_mul_f32 v230, v230, v30
  v_mfma_f32_16x16x32_bf16 v[32:35], a[84:87], a[36:39], v[32:35]
  v_mul_f32 v231, v231, v30
  v_exp_f32 v55, v55
  v_cvt_pk_bf16_f32 v224, v224, v225
  v_permlane16_swap_b32 v216, v218
  v_permlane16_swap_b32 v217, v219
  v_mfma_f32_16x16x32_bf16 v[32:35], a[88:91], a[40:43], v[32:35]
  buffer_store_dwordx4 v[208:211], v8, s[28:31], s39 offen offset:128 sc1
  v_cvt_pk_bf16_f32 v225, v226, v227
  v_cvt_pk_bf16_f32 v53, v54, v55
  v_cvt_pk_bf16_f32 v226, v228, v229
  v_mfma_f32_16x16x32_bf16 v[32:35], a[92:95], a[44:47], v[32:35]
  buffer_store_dwordx4 v[216:219], v8, s[28:31], s39 offen offset:192 sc1
  v_cvt_pk_bf16_f32 v227, v230, v231
  v_mfma_f32_16x16x32_bf16 v[40:43], a[64:67], a[48:51], v[22:25]
  v_permlane16_swap_b32 v224, v226
  v_permlane16_swap_b32 v225, v227
  v_exp_f32 v56, v56
  v_exp_f32 v48, v48
  v_mfma_f32_16x16x32_bf16 v[40:43], a[68:71], a[52:55], v[40:43]
  v_exp_f32 v57, v57
  v_mul_f32 v232, v232, v30
  v_exp_f32 v49, v49
  v_mfma_f32_16x16x32_bf16 v[40:43], a[72:75], a[56:59], v[40:43]
  v_mul_f32 v233, v233, v30
  v_cvt_pk_bf16_f32 v56, v56, v57
  v_mul_f32 v234, v234, v30
  v_cvt_pk_bf16_f32 v54, v48, v49
  v_mfma_f32_16x16x32_bf16 v[40:43], a[76:79], a[60:63], v[40:43]
  v_mul_f32 v235, v235, v30
  v_mul_f32 v236, v236, v30
  v_mfma_f32_16x16x32_bf16 v[44:47], a[80:83], a[48:51], v[22:25]
  v_mul_f32 v237, v237, v30
  v_exp_f32 v58, v58
  v_mul_f32 v238, v238, v30
  v_exp_f32 v50, v50
  v_mfma_f32_16x16x32_bf16 v[44:47], a[84:87], a[52:55], v[44:47]
  v_mul_f32 v239, v239, v30
  v_exp_f32 v59, v59
  v_cvt_pk_bf16_f32 v232, v232, v233
  v_exp_f32 v51, v51
  v_mfma_f32_16x16x32_bf16 v[44:47], a[88:91], a[56:59], v[44:47]
  v_cvt_pk_bf16_f32 v233, v234, v235
  v_cvt_pk_bf16_f32 v57, v58, v59
  v_cvt_pk_bf16_f32 v234, v236, v237
  v_cvt_pk_bf16_f32 v55, v50, v51
  v_mfma_f32_16x16x32_bf16 v[44:47], a[92:95], a[60:63], v[44:47]
  v_cvt_pk_bf16_f32 v235, v238, v239
  v_mul_f32 v240, v240, v30
  v_mfma_f32_16x16x32_bf16 v[128:131], a[128:131], v[52:55], v[128:131]
  v_permlane16_swap_b32 v232, v234
  v_permlane16_swap_b32 v233, v235
  v_exp_f32 v60, v60
  v_mfma_f32_16x16x32_bf16 v[132:135], a[132:135], v[52:55], v[132:135]
  v_exp_f32 v61, v61
  v_mfma_f32_16x16x32_bf16 v[136:139], a[136:139], v[52:55], v[136:139]
  v_mul_f32 v241, v241, v30
  v_mul_f32 v242, v242, v30
  v_cvt_pk_bf16_f32 v58, v60, v61
  v_mfma_f32_16x16x32_bf16 v[140:143], a[140:143], v[52:55], v[140:143]
  v_mul_f32 v243, v243, v30
  v_mul_f32 v244, v244, v30
  v_mfma_f32_16x16x32_bf16 v[144:147], a[144:147], v[52:55], v[144:147]
  v_mul_f32 v245, v245, v30
  v_mul_f32 v246, v246, v30
  v_exp_f32 v62, v62
  v_mfma_f32_16x16x32_bf16 v[148:151], a[148:151], v[52:55], v[148:151]
  v_mul_f32 v247, v247, v30
  v_cvt_pk_bf16_f32 v240, v240, v241
  v_exp_f32 v63, v63
  v_mfma_f32_16x16x32_bf16 v[152:155], a[152:155], v[52:55], v[152:155]
  v_cvt_pk_bf16_f32 v241, v242, v243
  v_cvt_pk_bf16_f32 v242, v244, v245
  v_cvt_pk_bf16_f32 v59, v62, v63
  v_mfma_f32_16x16x32_bf16 v[156:159], a[156:159], v[52:55], v[156:159]
  v_cvt_pk_bf16_f32 v243, v246, v247
  v_mul_f32 v248, v248, v30
  v_smfmac_f32_16x16x64_bf16 a[196:199], a[204:207], v[52:59], v7
  buffer_store_dwordx4 v[224:227], v8, s[28:31], s40 offen sc1
  v_permlane16_swap_b32 v240, v242
  v_permlane16_swap_b32 v241, v243
  v_mfma_f32_16x16x32_bf16 v[160:163], a[128:131], v[56:59], v[160:163]
  buffer_store_dwordx4 v[232:235], v8, s[28:31], s40 offen offset:64 sc1
  v_mfma_f32_16x16x32_bf16 v[164:167], a[132:135], v[56:59], v[164:167]
  v_mul_f32 v249, v249, v30
  v_mul_f32 v250, v250, v30
  v_mfma_f32_16x16x32_bf16 v[168:171], a[136:139], v[56:59], v[168:171]
  v_mul_f32 v251, v251, v30
  v_mul_f32 v252, v252, v30
  v_mfma_f32_16x16x32_bf16 v[172:175], a[140:143], v[56:59], v[172:175]
  v_mul_f32 v253, v253, v30
  v_mul_f32 v254, v254, v30
  v_mfma_f32_16x16x32_bf16 v[176:179], a[144:147], v[56:59], v[176:179]
  v_mul_f32 v255, v255, v30
  v_cvt_pk_bf16_f32 v248, v248, v249
  v_mfma_f32_16x16x32_bf16 v[180:183], a[148:151], v[56:59], v[180:183]
  v_cvt_pk_bf16_f32 v249, v250, v251
  v_cvt_pk_bf16_f32 v250, v252, v253
  v_mfma_f32_16x16x32_bf16 v[184:187], a[152:155], v[56:59], v[184:187]
  ds_read_b64_tr_b16 v[192:193], v5 offset:18432
  v_cvt_pk_bf16_f32 v251, v254, v255
  v_mfma_f32_16x16x32_bf16 v[188:191], a[156:159], v[56:59], v[188:191]
  v_permlane16_swap_b32 v248, v250
  v_permlane16_swap_b32 v249, v251
  v_mfma_f32_16x16x32_bf16 v[52:55], a[64:67], a[0:3], v[10:13]
  v_exp_f32 v36, v36
  v_exp_f32 v40, v40
  v_mfma_f32_16x16x32_bf16 v[52:55], a[68:71], a[4:7], v[52:55]
  v_exp_f32 v37, v37
  v_exp_f32 v41, v41
  v_mfma_f32_16x16x32_bf16 v[52:55], a[72:75], a[8:11], v[52:55]
  v_cvt_pk_bf16_f32 v36, v36, v37
  v_cvt_pk_bf16_f32 v40, v40, v41
  v_mfma_f32_16x16x32_bf16 v[52:55], a[76:79], a[12:15], v[52:55]
  v_exp_f32 v38, v38
  v_mfma_f32_16x16x32_bf16 v[48:51], a[80:83], a[0:3], v[10:13]
  ds_read_b64_tr_b16 v[194:195], v5 offset:26624
  v_exp_f32 v42, v42
  v_mfma_f32_16x16x32_bf16 v[48:51], a[84:87], a[4:7], v[48:51]
  ds_read_b64_tr_b16 v[196:197], v6 offset:18432
  ds_read_b64_tr_b16 v[198:199], v6 offset:26624
  v_exp_f32 v39, v39
  v_exp_f32 v43, v43
  v_mfma_f32_16x16x32_bf16 v[48:51], a[88:91], a[8:11], v[48:51]
  ds_read_b64_tr_b16 v[200:201], v5 offset:18688
  ds_read_b64_tr_b16 v[202:203], v5 offset:26880
  v_cvt_pk_bf16_f32 v37, v38, v39
  v_cvt_pk_bf16_f32 v41, v42, v43
  v_mfma_f32_16x16x32_bf16 v[48:51], a[92:95], a[12:15], v[48:51]
  ds_read_b64_tr_b16 v[204:205], v6 offset:18688
  ds_read_b64_tr_b16 v[206:207], v6 offset:26880
  v_mfma_f32_16x16x32_bf16 v[56:59], a[64:67], a[16:19], v[14:17]
  ds_read_b64_tr_b16 v[208:209], v5 offset:18944
  ds_read_b64_tr_b16 v[210:211], v5 offset:27136
  v_exp_f32 v32, v32
  v_exp_f32 v44, v44
  v_mfma_f32_16x16x32_bf16 v[56:59], a[68:71], a[20:23], v[56:59]
  buffer_store_dwordx4 v[240:243], v8, s[28:31], s40 offen offset:128 sc1
  ds_read_b64_tr_b16 v[212:213], v6 offset:18944
  ds_read_b64_tr_b16 v[214:215], v6 offset:27136
  v_exp_f32 v33, v33
  v_exp_f32 v45, v45
  v_mfma_f32_16x16x32_bf16 v[56:59], a[72:75], a[24:27], v[56:59]
  buffer_store_dwordx4 v[248:251], v8, s[28:31], s40 offen offset:192 sc1
  ds_read_b64_tr_b16 v[216:217], v5 offset:19200
  ds_read_b64_tr_b16 v[218:219], v5 offset:27392
  v_cvt_pk_bf16_f32 v38, v32, v33
  v_cvt_pk_bf16_f32 v42, v44, v45
  v_mfma_f32_16x16x32_bf16 v[56:59], a[76:79], a[28:31], v[56:59]
  ds_read_b64_tr_b16 v[220:221], v6 offset:19200
  ds_read_b64_tr_b16 v[222:223], v6 offset:27392
  v_mfma_f32_16x16x32_bf16 v[60:63], a[80:83], a[16:19], v[14:17]
  v_exp_f32 v34, v34
  v_exp_f32 v46, v46
  v_mfma_f32_16x16x32_bf16 v[60:63], a[84:87], a[20:23], v[60:63]
  v_exp_f32 v35, v35
  v_exp_f32 v47, v47
  v_mfma_f32_16x16x32_bf16 v[60:63], a[88:91], a[24:27], v[60:63]
  v_cvt_pk_bf16_f32 v39, v34, v35
  v_cvt_pk_bf16_f32 v43, v46, v47
  v_mfma_f32_16x16x32_bf16 v[60:63], a[92:95], a[28:31], v[60:63]
  v_exp_f32 v52, v52
  v_smfmac_f32_16x16x64_bf16 a[196:199], a[204:207], v[36:43], v7
  s_waitcnt lgkmcnt(10)
  v_add_u32 v4, 0xffff0000, v4
  v_mfma_f32_16x16x32_bf16 v[128:131], v[192:195], v[36:39], v[128:131]
  s_xor_b32 s39, s34, 32768
  v_exp_f32 v53, v53
  v_mfma_f32_16x16x32_bf16 v[132:135], v[196:199], v[36:39], v[132:135]
  v_accvgpr_read_b32 v18, a196
  v_accvgpr_read_b32 v19, a197
  v_mfma_f32_16x16x32_bf16 v[136:139], v[200:203], v[36:39], v[136:139]
  s_waitcnt lgkmcnt(4)
  v_add_f32 v18, v18, v19
  v_cmp_nge_f32 s[52:53], s37, v18
  v_mfma_f32_16x16x32_bf16 v[140:143], v[204:207], v[36:39], v[140:143]
  v_rcp_f32 v18, v18
  v_mfma_f32_16x16x32_bf16 v[144:147], v[208:211], v[36:39], v[144:147]
  v_mul_f32 v128, v128, v18
  v_mul_f32 v129, v129, v18
  v_mfma_f32_16x16x32_bf16 v[148:151], v[212:215], v[36:39], v[148:151]
  s_waitcnt lgkmcnt(0)
  v_mul_f32 v130, v130, v18
  v_mul_f32 v131, v131, v18
  v_mfma_f32_16x16x32_bf16 v[152:155], v[216:219], v[36:39], v[152:155]
  v_mul_f32 v132, v132, v18
  v_mul_f32 v133, v133, v18
  v_mfma_f32_16x16x32_bf16 v[156:159], v[220:223], v[36:39], v[156:159]
  v_cvt_pk_bf16_f32 v52, v52, v53
  v_mul_f32 v134, v134, v18
  v_mfma_f32_16x16x32_bf16 v[160:163], v[192:195], v[40:43], v[160:163]
  v_accvgpr_read_b32 v22, a198
  v_accvgpr_read_b32 v23, a199
  v_add_f32 v22, v22, v23
  v_cmp_nge_f32 s[54:55], s37, v22
  v_rcp_f32 v22, v22
  v_mfma_f32_16x16x32_bf16 v[164:167], v[196:199], v[40:43], v[164:167]
  s_xor_b32 s40, s34, 49152
  v_mul_f32 v135, v135, v18
  v_cvt_pk_bf16_f32 v128, v128, v129
  v_mfma_f32_16x16x32_bf16 v[168:171], v[200:203], v[40:43], v[168:171]
  v_cvt_pk_bf16_f32 v129, v130, v131
  v_cvt_pk_bf16_f32 v130, v132, v133
  v_mfma_f32_16x16x32_bf16 v[172:175], v[204:207], v[40:43], v[172:175]
  v_exp_f32 v54, v54
  v_mfma_f32_16x16x32_bf16 v[176:179], v[208:211], v[40:43], v[176:179]
  v_cvt_pk_bf16_f32 v131, v134, v135
  v_mul_f32 v136, v136, v18
  v_mfma_f32_16x16x32_bf16 v[180:183], v[212:215], v[40:43], v[180:183]
  v_exp_f32 v55, v55
  v_permlane16_swap_b32 v128, v130
  v_permlane16_swap_b32 v129, v131
  v_mfma_f32_16x16x32_bf16 v[184:187], v[216:219], v[40:43], v[184:187]
  v_cvt_pk_bf16_f32 v53, v54, v55
  v_mul_f32 v137, v137, v18
  v_mfma_f32_16x16x32_bf16 v[188:191], v[220:223], v[40:43], v[188:191]
  v_mul_f32 v138, v138, v18
  v_mul_f32 v139, v139, v18
  v_mfma_f32_16x16x32_bf16 v[36:39], a[96:99], a[0:3], v[10:13]
  v_exp_f32 v56, v56
  v_mul_f32 v140, v140, v18
  v_exp_f32 v48, v48
  v_mfma_f32_16x16x32_bf16 v[36:39], a[100:103], a[4:7], v[36:39]
  v_mul_f32 v141, v141, v18
  v_exp_f32 v57, v57
  v_mul_f32 v142, v142, v18
  v_exp_f32 v49, v49
  v_mul_f32 v143, v143, v18
  v_mfma_f32_16x16x32_bf16 v[36:39], a[104:107], a[8:11], v[36:39]
  v_cvt_pk_bf16_f32 v56, v56, v57
  v_cvt_pk_bf16_f32 v136, v136, v137
  v_cvt_pk_bf16_f32 v137, v138, v139
  v_cvt_pk_bf16_f32 v54, v48, v49
  v_mfma_f32_16x16x32_bf16 v[36:39], a[108:111], a[12:15], v[36:39]
  v_cvt_pk_bf16_f32 v138, v140, v141
  v_cvt_pk_bf16_f32 v139, v142, v143
  v_mfma_f32_16x16x32_bf16 v[32:35], a[112:115], a[0:3], v[10:13]
  v_permlane16_swap_b32 v136, v138
  v_permlane16_swap_b32 v137, v139
  v_exp_f32 v58, v58
  v_exp_f32 v50, v50
  v_mfma_f32_16x16x32_bf16 v[32:35], a[116:119], a[4:7], v[32:35]
  buffer_store_dwordx4 v[128:131], v8, s[28:31], s39 offen sc1
  v_exp_f32 v59, v59
  v_mul_f32 v144, v144, v18
  v_exp_f32 v51, v51
  v_mfma_f32_16x16x32_bf16 v[32:35], a[120:123], a[8:11], v[32:35]
  buffer_store_dwordx4 v[136:139], v8, s[28:31], s39 offen offset:64 sc1
  v_mul_f32 v145, v145, v18
  v_cvt_pk_bf16_f32 v57, v58, v59
  v_mul_f32 v146, v146, v18
  v_cvt_pk_bf16_f32 v55, v50, v51
  v_mfma_f32_16x16x32_bf16 v[32:35], a[124:127], a[12:15], v[32:35]
  v_mul_f32 v147, v147, v18
  v_mul_f32 v148, v148, v18
  v_mul_f32 v149, v149, v18
  v_mfma_f32_16x16x32_bf16 v[64:67], v[192:195], v[52:55], v[64:67]
  v_mul_f32 v150, v150, v18
  v_mul_f32 v151, v151, v18
  v_exp_f32 v60, v60
  v_mfma_f32_16x16x32_bf16 v[68:71], v[196:199], v[52:55], v[68:71]
  v_cvt_pk_bf16_f32 v144, v144, v145
  v_cvt_pk_bf16_f32 v145, v146, v147
  v_exp_f32 v61, v61
  v_mfma_f32_16x16x32_bf16 v[72:75], v[200:203], v[52:55], v[72:75]
  v_cvt_pk_bf16_f32 v146, v148, v149
  v_cvt_pk_bf16_f32 v147, v150, v151
  v_cvt_pk_bf16_f32 v58, v60, v61
  v_mfma_f32_16x16x32_bf16 v[76:79], v[204:207], v[52:55], v[76:79]
  v_permlane16_swap_b32 v144, v146
  v_permlane16_swap_b32 v145, v147
  v_mfma_f32_16x16x32_bf16 v[80:83], v[208:211], v[52:55], v[80:83]
  v_mul_f32 v152, v152, v18
  v_exp_f32 v62, v62
  v_mfma_f32_16x16x32_bf16 v[84:87], v[212:215], v[52:55], v[84:87]
  v_mul_f32 v153, v153, v18
  v_mul_f32 v154, v154, v18
  v_mul_f32 v155, v155, v18
  v_exp_f32 v63, v63
  v_mfma_f32_16x16x32_bf16 v[88:91], v[216:219], v[52:55], v[88:91]
  v_mul_f32 v156, v156, v18
  v_mul_f32 v157, v157, v18
  v_cvt_pk_bf16_f32 v59, v62, v63
  v_mfma_f32_16x16x32_bf16 v[92:95], v[220:223], v[52:55], v[92:95]
  v_mul_f32 v158, v158, v18
  v_mul_f32 v159, v159, v18
  v_smfmac_f32_16x16x64_bf16 a[192:195], a[204:207], v[52:59], v7
  v_cvt_pk_bf16_f32 v152, v152, v153
  v_cvt_pk_bf16_f32 v153, v154, v155
  v_cvt_pk_bf16_f32 v154, v156, v157
  v_mfma_f32_16x16x32_bf16 v[96:99], v[192:195], v[56:59], v[96:99]
  v_mul_f32 v160, v160, v22
  v_exp_f32 v36, v36
  v_cvt_pk_bf16_f32 v155, v158, v159
  v_mul_f32 v161, v161, v22
  v_mfma_f32_16x16x32_bf16 v[100:103], v[196:199], v[56:59], v[100:103]
  v_mul_f32 v162, v162, v22
  v_permlane16_swap_b32 v152, v154
  v_permlane16_swap_b32 v153, v155
  v_exp_f32 v37, v37
  v_mul_f32 v163, v163, v22
  v_mfma_f32_16x16x32_bf16 v[104:107], v[200:203], v[56:59], v[104:107]
  v_cvt_pk_bf16_f32 v36, v36, v37
  v_mul_f32 v164, v164, v22
  v_mul_f32 v165, v165, v22
  v_mfma_f32_16x16x32_bf16 v[108:111], v[204:207], v[56:59], v[108:111]
  v_mul_f32 v166, v166, v22
  v_mul_f32 v167, v167, v22
  v_mfma_f32_16x16x32_bf16 v[112:115], v[208:211], v[56:59], v[112:115]
  v_exp_f32 v38, v38
  v_cvt_pk_bf16_f32 v160, v160, v161
  v_mfma_f32_16x16x32_bf16 v[116:119], v[212:215], v[56:59], v[116:119]
  v_cvt_pk_bf16_f32 v161, v162, v163
  v_exp_f32 v39, v39
  v_cvt_pk_bf16_f32 v162, v164, v165
  v_mfma_f32_16x16x32_bf16 v[120:123], v[216:219], v[56:59], v[120:123]
  v_cvt_pk_bf16_f32 v163, v166, v167
  v_cvt_pk_bf16_f32 v37, v38, v39
  v_mfma_f32_16x16x32_bf16 v[124:127], v[220:223], v[56:59], v[124:127]
  v_permlane16_swap_b32 v160, v162
  v_permlane16_swap_b32 v161, v163
  v_mfma_f32_16x16x32_bf16 v[40:43], a[160:163], a[0:3], v[10:13]
  buffer_store_dwordx4 v[144:147], v8, s[28:31], s39 offen offset:128 sc1
  v_exp_f32 v32, v32
  v_add_u32 v5, 0xffff0000, v5
  v_add_u32 v6, 0xffff0000, v6
  v_mfma_f32_16x16x32_bf16 v[40:43], a[164:167], a[4:7], v[40:43]
  buffer_store_dwordx4 v[152:155], v8, s[28:31], s39 offen offset:192 sc1
  v_mul_f32 v168, v168, v22
  v_mul_f32 v169, v169, v22
  v_exp_f32 v33, v33
  v_mfma_f32_16x16x32_bf16 v[40:43], a[168:171], a[8:11], v[40:43]
  v_mul_f32 v170, v170, v22
  v_cvt_pk_bf16_f32 v38, v32, v33
  v_mul_f32 v171, v171, v22
  v_mfma_f32_16x16x32_bf16 v[40:43], a[172:175], a[12:15], v[40:43]
  v_mul_f32 v172, v172, v22
  v_mul_f32 v173, v173, v22
  v_mfma_f32_16x16x32_bf16 v[44:47], a[176:179], a[0:3], v[10:13]
  v_mul_f32 v174, v174, v22
  v_exp_f32 v34, v34
  v_mfma_f32_16x16x32_bf16 v[44:47], a[180:183], a[4:7], v[44:47]
  v_mul_f32 v175, v175, v22
  v_cvt_pk_bf16_f32 v168, v168, v169
  v_exp_f32 v35, v35
  v_mfma_f32_16x16x32_bf16 v[44:47], a[184:187], a[8:11], v[44:47]
  ds_read_b128 a[32:35], v4 offset:49152
  ds_read_b128 a[36:39], v4 offset:49408
  ds_read_b128 a[40:43], v4 offset:49664
  ds_read_b128 a[44:47], v4 offset:49920
  v_cvt_pk_bf16_f32 v169, v170, v171
  v_cvt_pk_bf16_f32 v170, v172, v173
  v_cvt_pk_bf16_f32 v39, v34, v35
  v_mfma_f32_16x16x32_bf16 v[44:47], a[188:191], a[12:15], v[44:47]
  v_cvt_pk_bf16_f32 v171, v174, v175
  v_mul_f32 v176, v176, v22
  v_mfma_f32_16x16x32_bf16 v[64:67], a[128:131], v[36:39], v[64:67]
  v_exp_f32 v40, v40
  v_permlane16_swap_b32 v168, v170
  v_permlane16_swap_b32 v169, v171
  v_mfma_f32_16x16x32_bf16 v[68:71], a[132:135], v[36:39], v[68:71]
  v_exp_f32 v41, v41
  v_mfma_f32_16x16x32_bf16 v[72:75], a[136:139], v[36:39], v[72:75]
  ds_read_b128 a[48:51], v4 offset:57344
  ds_read_b128 a[52:55], v4 offset:57600
  ds_read_b128 a[56:59], v4 offset:57856
  ds_read_b128 a[60:63], v4 offset:58112
  v_cvt_pk_bf16_f32 v40, v40, v41
  v_mul_f32 v177, v177, v22
  v_add_u32 v4, 0x10000, v4
  v_mfma_f32_16x16x32_bf16 v[76:79], a[140:143], v[36:39], v[76:79]
  v_mul_f32 v178, v178, v22
  v_mul_f32 v179, v179, v22
  v_mfma_f32_16x16x32_bf16 v[80:83], a[144:147], v[36:39], v[80:83]
  v_exp_f32 v42, v42
  v_mul_f32 v180, v180, v22
  v_mfma_f32_16x16x32_bf16 v[84:87], a[148:151], v[36:39], v[84:87]
  v_mul_f32 v181, v181, v22
  v_exp_f32 v43, v43
  v_mul_f32 v182, v182, v22
  v_mfma_f32_16x16x32_bf16 v[88:91], a[152:155], v[36:39], v[88:91]
  v_mul_f32 v183, v183, v22
  v_cvt_pk_bf16_f32 v41, v42, v43
  v_cvt_pk_bf16_f32 v176, v176, v177
  v_mfma_f32_16x16x32_bf16 v[92:95], a[156:159], v[36:39], v[92:95]
  s_waitcnt lgkmcnt(7)
  v_cvt_pk_bf16_f32 v177, v178, v179
  v_cvt_pk_bf16_f32 v178, v180, v181
  v_mfma_f32_16x16x32_bf16 v[52:55], a[32:35], a[0:3], v[10:13]
  s_waitcnt lgkmcnt(4)
  v_cvt_pk_bf16_f32 v179, v182, v183
  v_exp_f32 v44, v44
  v_mfma_f32_16x16x32_bf16 v[52:55], a[36:39], a[4:7], v[52:55]
  v_permlane16_swap_b32 v176, v178
  v_permlane16_swap_b32 v177, v179
  v_exp_f32 v45, v45
  v_mfma_f32_16x16x32_bf16 v[52:55], a[40:43], a[8:11], v[52:55]
  v_cvt_pk_bf16_f32 v42, v44, v45
  v_mul_f32 v184, v184, v22
  v_mfma_f32_16x16x32_bf16 v[52:55], a[44:47], a[12:15], v[52:55]
  s_waitcnt lgkmcnt(3)
  v_mul_f32 v185, v185, v22
  v_mul_f32 v186, v186, v22
  v_mfma_f32_16x16x32_bf16 v[48:51], a[48:51], a[0:3], v[10:13]
  s_waitcnt lgkmcnt(0)
  buffer_store_dwordx4 v[160:163], v8, s[28:31], s40 offen sc1
  v_exp_f32 v46, v46
  v_mfma_f32_16x16x32_bf16 v[48:51], a[52:55], a[4:7], v[48:51]
  buffer_store_dwordx4 v[168:171], v8, s[28:31], s40 offen offset:64 sc1
  v_mul_f32 v187, v187, v22
  v_mul_f32 v188, v188, v22
  v_exp_f32 v47, v47
  v_mfma_f32_16x16x32_bf16 v[48:51], a[56:59], a[8:11], v[48:51]
  v_mul_f32 v189, v189, v22
  v_mul_f32 v190, v190, v22
  v_cvt_pk_bf16_f32 v43, v46, v47
  v_mfma_f32_16x16x32_bf16 v[48:51], a[60:63], a[12:15], v[48:51]
  ds_read_b128 a[64:67], v4 offset:0
  ds_read_b128 a[68:71], v4 offset:256
  ds_read_b128 a[72:75], v4 offset:512
  ds_read_b128 a[76:79], v4 offset:768
  v_mul_f32 v191, v191, v22
  v_smfmac_f32_16x16x64_bf16 a[192:195], a[212:215], v[36:43], v7
  v_cvt_pk_bf16_f32 v184, v184, v185
  v_cvt_pk_bf16_f32 v185, v186, v187
  v_mfma_f32_16x16x32_bf16 v[64:67], a[224:227], v[40:43], v[64:67]
  v_cvt_pk_bf16_f32 v186, v188, v189
  v_exp_f32 v52, v52
  v_cvt_pk_bf16_f32 v187, v190, v191
  v_mfma_f32_16x16x32_bf16 v[68:71], a[228:231], v[40:43], v[68:71]
  v_exp_f32 v53, v53
  v_permlane16_swap_b32 v184, v186
  v_permlane16_swap_b32 v185, v187
  v_mfma_f32_16x16x32_bf16 v[72:75], a[232:235], v[40:43], v[72:75]
  ds_read_b128 a[80:83], v4 offset:8192
  ds_read_b128 a[84:87], v4 offset:8448
  ds_read_b128 a[88:91], v4 offset:8704
  ds_read_b128 a[92:95], v4 offset:8960
  v_cvt_pk_bf16_f32 v52, v52, v53
  v_mfma_f32_16x16x32_bf16 v[76:79], a[236:239], v[40:43], v[76:79]
  ds_read_b64_tr_b16 v[224:225], v5 offset:51200
  ds_read_b64_tr_b16 v[226:227], v5 offset:59392
  v_mfma_f32_16x16x32_bf16 v[80:83], a[240:243], v[40:43], v[80:83]
  ds_read_b64_tr_b16 v[228:229], v6 offset:51200
  ds_read_b64_tr_b16 v[230:231], v6 offset:59392
  v_exp_f32 v54, v54
  v_mfma_f32_16x16x32_bf16 v[84:87], a[244:247], v[40:43], v[84:87]
  ds_read_b64_tr_b16 v[232:233], v5 offset:51456
  ds_read_b64_tr_b16 v[234:235], v5 offset:59648
  v_exp_f32 v55, v55
  v_mfma_f32_16x16x32_bf16 v[88:91], a[248:251], v[40:43], v[88:91]
  ds_read_b64_tr_b16 v[236:237], v6 offset:51456
  ds_read_b64_tr_b16 v[238:239], v6 offset:59648
  v_cvt_pk_bf16_f32 v53, v54, v55
  v_mfma_f32_16x16x32_bf16 v[92:95], a[252:255], v[40:43], v[92:95]
  s_waitcnt lgkmcnt(15)
  ds_read_b64_tr_b16 v[240:241], v5 offset:51712
  ds_read_b64_tr_b16 v[242:243], v5 offset:59904
  v_mfma_f32_16x16x32_bf16 v[56:59], a[64:67], a[0:3], v[10:13]
L_isl6:
  s_cbranch_execz L_retB
  s_waitcnt lgkmcnt(14)
  ds_read_b64_tr_b16 v[244:245], v6 offset:51712
  ds_read_b64_tr_b16 v[246:247], v6 offset:59904
  v_exp_f32 v48, v48
  v_mfma_f32_16x16x32_bf16 v[56:59], a[68:71], a[4:7], v[56:59]
  ds_read_b64_tr_b16 v[248:249], v5 offset:51968
  ds_read_b64_tr_b16 v[250:251], v5 offset:60160
  v_exp_f32 v49, v49
  v_mfma_f32_16x16x32_bf16 v[56:59], a[72:75], a[8:11], v[56:59]
  ds_read_b64_tr_b16 v[252:253], v6 offset:51968
  ds_read_b64_tr_b16 v[254:255], v6 offset:60160
  v_cvt_pk_bf16_f32 v54, v48, v49
  v_add_u32 v5, 0x10000, v5
  v_add_u32 v6, 0x10000, v6
  v_mfma_f32_16x16x32_bf16 v[56:59], a[76:79], a[12:15], v[56:59]
  s_waitcnt lgkmcnt(15)
  v_exp_f32 v50, v50
  v_mfma_f32_16x16x32_bf16 v[60:63], a[80:83], a[0:3], v[10:13]
  v_exp_f32 v51, v51
  v_mfma_f32_16x16x32_bf16 v[60:63], a[84:87], a[4:7], v[60:63]
  ds_read_b64_tr_b16 v[192:193], v5 offset:2048
  v_cvt_pk_bf16_f32 v55, v50, v51
  v_mfma_f32_16x16x32_bf16 v[60:63], a[88:91], a[8:11], v[60:63]
  v_exp_f32 v56, v56
  v_mfma_f32_16x16x32_bf16 v[60:63], a[92:95], a[12:15], v[60:63]
  s_waitcnt lgkmcnt(11)
  buffer_store_dwordx4 v[176:179], v8, s[28:31], s40 offen offset:128 sc1
  v_mfma_f32_16x16x32_bf16 v[64:67], v[224:227], v[52:55], v[64:67]
  buffer_store_dwordx4 v[184:187], v8, s[28:31], s40 offen offset:192 sc1
  v_mfma_f32_16x16x32_bf16 v[68:71], v[228:231], v[52:55], v[68:71]
  v_exp_f32 v57, v57
  v_mfma_f32_16x16x32_bf16 v[72:75], v[232:235], v[52:55], v[72:75]
  s_waitcnt lgkmcnt(5)
  ds_read_b64_tr_b16 v[194:195], v5 offset:10240
  v_cvt_pk_bf16_f32 v56, v56, v57
  v_mfma_f32_16x16x32_bf16 v[76:79], v[236:239], v[52:55], v[76:79]
  v_exp_f32 v58, v58
  v_mfma_f32_16x16x32_bf16 v[80:83], v[240:243], v[52:55], v[80:83]
  v_exp_f32 v59, v59
  v_mfma_f32_16x16x32_bf16 v[84:87], v[244:247], v[52:55], v[84:87]
  s_waitcnt lgkmcnt(2)
  ds_read_b64_tr_b16 v[196:197], v6 offset:2048
  ds_read_b64_tr_b16 v[198:199], v6 offset:10240
  v_mfma_f32_16x16x32_bf16 v[88:91], v[248:251], v[52:55], v[88:91]
  ds_read_b64_tr_b16 v[200:201], v5 offset:2304
  ds_read_b64_tr_b16 v[202:203], v5 offset:10496
  v_cvt_pk_bf16_f32 v57, v58, v59
  v_mfma_f32_16x16x32_bf16 v[92:95], v[252:255], v[52:55], v[92:95]
  ds_read_b64_tr_b16 v[204:205], v6 offset:2304
  ds_read_b64_tr_b16 v[206:207], v6 offset:10496
  v_mfma_f32_16x16x32_bf16 v[36:39], a[64:67], a[16:19], v[14:17]
  ds_read_b64_tr_b16 v[208:209], v5 offset:2560
  ds_read_b64_tr_b16 v[210:211], v5 offset:10752
  v_exp_f32 v60, v60
  v_mfma_f32_16x16x32_bf16 v[36:39], a[68:71], a[20:23], v[36:39]
  ds_read_b64_tr_b16 v[212:213], v6 offset:2560
  ds_read_b64_tr_b16 v[214:215], v6 offset:10752
  v_exp_f32 v61, v61
  v_mfma_f32_16x16x32_bf16 v[36:39], a[72:75], a[24:27], v[36:39]
  ds_read_b64_tr_b16 v[216:217], v5 offset:2816
  ds_read_b64_tr_b16 v[218:219], v5 offset:11008
  v_cvt_pk_bf16_f32 v58, v60, v61
  v_mfma_f32_16x16x32_bf16 v[36:39], a[76:79], a[28:31], v[36:39]
  ds_read_b64_tr_b16 v[220:221], v6 offset:2816
  ds_read_b64_tr_b16 v[222:223], v6 offset:11008
  v_mfma_f32_16x16x32_bf16 v[32:35], a[80:83], a[16:19], v[14:17]
  v_exp_f32 v62, v62
  v_mfma_f32_16x16x32_bf16 v[32:35], a[84:87], a[20:23], v[32:35]
  v_exp_f32 v63, v63
  v_mfma_f32_16x16x32_bf16 v[32:35], a[88:91], a[24:27], v[32:35]
  v_cvt_pk_bf16_f32 v59, v62, v63
  v_mfma_f32_16x16x32_bf16 v[32:35], a[92:95], a[28:31], v[32:35]
  v_exp_f32 v36, v36
  v_smfmac_f32_16x16x64_bf16 a[192:195], a[212:215], v[52:59], v7
  s_waitcnt lgkmcnt(10)
  v_mfma_f32_16x16x32_bf16 v[64:67], v[192:195], v[56:59], v[64:67]
  s_xor_b32 s39, s34, 0
  v_exp_f32 v37, v37
  v_mfma_f32_16x16x32_bf16 v[68:71], v[196:199], v[56:59], v[68:71]
  v_accvgpr_read_b32 v10, a192
  v_accvgpr_read_b32 v11, a193
  v_mfma_f32_16x16x32_bf16 v[72:75], v[200:203], v[56:59], v[72:75]
  s_waitcnt lgkmcnt(4)
  v_cvt_pk_bf16_f32 v36, v36, v37
  v_add_f32 v10, v10, v11
  v_mfma_f32_16x16x32_bf16 v[76:79], v[204:207], v[56:59], v[76:79]
  v_cmp_nge_f32 s[48:49], s37, v10
  v_rcp_f32 v10, v10
  v_mfma_f32_16x16x32_bf16 v[80:83], v[208:211], v[56:59], v[80:83]
  v_exp_f32 v38, v38
  v_mfma_f32_16x16x32_bf16 v[84:87], v[212:215], v[56:59], v[84:87]
  s_waitcnt lgkmcnt(0)
  v_exp_f32 v39, v39
  v_mfma_f32_16x16x32_bf16 v[88:91], v[216:219], v[56:59], v[88:91]
  v_cvt_pk_bf16_f32 v37, v38, v39
  v_mul_f32 v64, v64, v10
  v_mfma_f32_16x16x32_bf16 v[92:95], v[220:223], v[56:59], v[92:95]
  v_mul_f32 v65, v65, v10
  v_mul_f32 v66, v66, v10
  v_mul_f32 v67, v67, v10
  v_mfma_f32_16x16x32_bf16 v[40:43], a[32:35], a[16:19], v[14:17]
  v_mul_f32 v68, v68, v10
  v_mul_f32 v69, v69, v10
  v_mul_f32 v70, v70, v10
  v_exp_f32 v32, v32
  v_mfma_f32_16x16x32_bf16 v[40:43], a[36:39], a[20:23], v[40:43]
  v_mul_f32 v71, v71, v10
  v_cvt_pk_bf16_f32 v64, v64, v65
  v_cvt_pk_bf16_f32 v65, v66, v67
  v_exp_f32 v33, v33
  v_cvt_pk_bf16_f32 v66, v68, v69
  v_mfma_f32_16x16x32_bf16 v[40:43], a[40:43], a[24:27], v[40:43]
  v_cvt_pk_bf16_f32 v67, v70, v71
  v_cvt_pk_bf16_f32 v38, v32, v33
  v_mfma_f32_16x16x32_bf16 v[40:43], a[44:47], a[28:31], v[40:43]
  v_permlane16_swap_b32 v64, v66
  v_permlane16_swap_b32 v65, v67
  v_mul_f32 v72, v72, v10
  v_mul_f32 v73, v73, v10
  v_mfma_f32_16x16x32_bf16 v[44:47], a[48:51], a[16:19], v[14:17]
  v_mul_f32 v74, v74, v10
  v_mul_f32 v75, v75, v10
  v_mul_f32 v76, v76, v10
  v_exp_f32 v34, v34
  v_mfma_f32_16x16x32_bf16 v[44:47], a[52:55], a[20:23], v[44:47]
  v_mul_f32 v77, v77, v10
  v_mul_f32 v78, v78, v10
  v_mul_f32 v79, v79, v10
  v_cvt_pk_bf16_f32 v72, v72, v73
  v_exp_f32 v35, v35
  v_mfma_f32_16x16x32_bf16 v[44:47], a[56:59], a[24:27], v[44:47]
  v_cvt_pk_bf16_f32 v73, v74, v75
  v_cvt_pk_bf16_f32 v74, v76, v77
  v_cvt_pk_bf16_f32 v75, v78, v79
  v_cvt_pk_bf16_f32 v39, v34, v35
  v_mfma_f32_16x16x32_bf16 v[44:47], a[60:63], a[28:31], v[44:47]
  v_permlane16_swap_b32 v72, v74
  v_permlane16_swap_b32 v73, v75
  v_mfma_f32_16x16x32_bf16 v[96:99], v[192:195], v[36:39], v[96:99]
  buffer_store_dwordx4 v[64:67], v8, s[28:31], s39 offen sc1
  v_mul_f32 v80, v80, v10
  v_exp_f32 v40, v40
  v_mul_f32 v81, v81, v10
  v_mul_f32 v82, v82, v10
  v_mfma_f32_16x16x32_bf16 v[100:103], v[196:199], v[36:39], v[100:103]
  buffer_store_dwordx4 v[72:75], v8, s[28:31], s39 offen offset:64 sc1
  v_mul_f32 v83, v83, v10
  v_exp_f32 v41, v41
  v_mul_f32 v84, v84, v10
  v_mul_f32 v85, v85, v10
  v_mul_f32 v86, v86, v10
  v_mfma_f32_16x16x32_bf16 v[104:107], v[200:203], v[36:39], v[104:107]
  v_mul_f32 v87, v87, v10
  v_cvt_pk_bf16_f32 v40, v40, v41
  v_cvt_pk_bf16_f32 v80, v80, v81
  v_cvt_pk_bf16_f32 v81, v82, v83
  v_mfma_f32_16x16x32_bf16 v[108:111], v[204:207], v[36:39], v[108:111]
  v_cvt_pk_bf16_f32 v82, v84, v85
  v_cvt_pk_bf16_f32 v83, v86, v87
  v_mfma_f32_16x16x32_bf16 v[112:115], v[208:211], v[36:39], v[112:115]
  v_permlane16_swap_b32 v80, v82
  v_permlane16_swap_b32 v81, v83
  v_exp_f32 v42, v42
  v_mul_f32 v88, v88, v10
  v_mfma_f32_16x16x32_bf16 v[116:119], v[212:215], v[36:39], v[116:119]
  v_mul_f32 v89, v89, v10
  v_mul_f32 v90, v90, v10
  v_exp_f32 v43, v43
  v_mul_f32 v91, v91, v10
  v_mul_f32 v92, v92, v10
  v_mfma_f32_16x16x32_bf16 v[120:123], v[216:219], v[36:39], v[120:123]
  v_mul_f32 v93, v93, v10
  v_mul_f32 v94, v94, v10
  v_cvt_pk_bf16_f32 v41, v42, v43
  v_mul_f32 v95, v95, v10
  v_mfma_f32_16x16x32_bf16 v[124:127], v[220:223], v[36:39], v[124:127]
  v_cvt_pk_bf16_f32 v88, v88, v89
  v_cvt_pk_bf16_f32 v89, v90, v91
  v_cvt_pk_bf16_f32 v90, v92, v93
  v_cvt_pk_bf16_f32 v91, v94, v95
  v_mfma_f32_16x16x32_bf16 v[52:55], a[160:163], a[16:19], v[14:17]
  v_permlane16_swap_b32 v88, v90
  v_permlane16_swap_b32 v89, v91
  v_exp_f32 v44, v44
  v_mfma_f32_16x16x32_bf16 v[52:55], a[164:167], a[20:23], v[52:55]
  v_exp_f32 v45, v45
  v_mfma_f32_16x16x32_bf16 v[52:55], a[168:171], a[24:27], v[52:55]
  v_cvt_pk_bf16_f32 v42, v44, v45
  v_mfma_f32_16x16x32_bf16 v[52:55], a[172:175], a[28:31], v[52:55]
  v_exp_f32 v46, v46
  v_mfma_f32_16x16x32_bf16 v[48:51], a[176:179], a[16:19], v[14:17]
  buffer_store_dwordx4 v[80:83], v8, s[28:31], s39 offen offset:128 sc1
  v_mfma_f32_16x16x32_bf16 v[48:51], a[180:183], a[20:23], v[48:51]
  buffer_store_dwordx4 v[88:91], v8, s[28:31], s39 offen offset:192 sc1
  v_exp_f32 v47, v47
  v_mfma_f32_16x16x32_bf16 v[48:51], a[184:187], a[24:27], v[48:51]
  v_cvt_pk_bf16_f32 v43, v46, v47
  v_mfma_f32_16x16x32_bf16 v[48:51], a[188:191], a[28:31], v[48:51]
  v_exp_f32 v52, v52
  v_smfmac_f32_16x16x64_bf16 a[192:195], a[216:219], v[36:43], v7
  v_mfma_f32_16x16x32_bf16 v[96:99], v[224:227], v[40:43], v[96:99]
  v_exp_f32 v53, v53
  v_mfma_f32_16x16x32_bf16 v[100:103], v[228:231], v[40:43], v[100:103]
  v_cvt_pk_bf16_f32 v52, v52, v53
  v_mfma_f32_16x16x32_bf16 v[104:107], v[232:235], v[40:43], v[104:107]
  v_exp_f32 v54, v54
  v_mfma_f32_16x16x32_bf16 v[108:111], v[236:239], v[40:43], v[108:111]
  v_exp_f32 v55, v55
  v_mfma_f32_16x16x32_bf16 v[112:115], v[240:243], v[40:43], v[112:115]
  v_cvt_pk_bf16_f32 v53, v54, v55
  v_mfma_f32_16x16x32_bf16 v[116:119], v[244:247], v[40:43], v[116:119]
  v_exp_f32 v48, v48
  v_mfma_f32_16x16x32_bf16 v[120:123], v[248:251], v[40:43], v[120:123]
  v_exp_f32 v49, v49
  v_mfma_f32_16x16x32_bf16 v[124:127], v[252:255], v[40:43], v[124:127]
  v_exp_f32 v50, v50
  v_mfma_f32_16x16x32_bf16 v[56:59], a[96:99], a[16:19], v[14:17]
  v_exp_f32 v51, v51
  v_mfma_f32_16x16x32_bf16 v[56:59], a[100:103], a[20:23], v[56:59]
  v_cvt_pk_bf16_f32 v54, v48, v49
  v_cvt_pk_bf16_f32 v55, v50, v51
  v_mfma_f32_16x16x32_bf16 v[56:59], a[104:107], a[24:27], v[56:59]
  v_mfma_f32_16x16x32_bf16 v[56:59], a[108:111], a[28:31], v[56:59]
  v_mfma_f32_16x16x32_bf16 v[60:63], a[112:115], a[16:19], v[14:17]
  v_mfma_f32_16x16x32_bf16 v[60:63], a[116:119], a[20:23], v[60:63]
  v_exp_f32 v56, v56
  v_mfma_f32_16x16x32_bf16 v[60:63], a[120:123], a[24:27], v[60:63]
  v_exp_f32 v57, v57
  v_mfma_f32_16x16x32_bf16 v[60:63], a[124:127], a[28:31], v[60:63]
  v_cvt_pk_bf16_f32 v56, v56, v57
  v_mfma_f32_16x16x32_bf16 v[96:99], a[224:227], v[52:55], v[96:99]
  v_exp_f32 v58, v58
  v_mfma_f32_16x16x32_bf16 v[100:103], a[228:231], v[52:55], v[100:103]
  v_exp_f32 v59, v59
  v_mfma_f32_16x16x32_bf16 v[104:107], a[232:235], v[52:55], v[104:107]
  v_cvt_pk_bf16_f32 v57, v58, v59
  v_exp_f32 v60, v60
  v_mfma_f32_16x16x32_bf16 v[108:111], a[236:239], v[52:55], v[108:111]
  v_exp_f32 v61, v61
  v_mfma_f32_16x16x32_bf16 v[112:115], a[240:243], v[52:55], v[112:115]
  v_cvt_pk_bf16_f32 v58, v60, v61
  v_exp_f32 v62, v62
  v_mfma_f32_16x16x32_bf16 v[116:119], a[244:247], v[52:55], v[116:119]
  v_exp_f32 v63, v63
  v_mfma_f32_16x16x32_bf16 v[120:123], a[248:251], v[52:55], v[120:123]
  v_cvt_pk_bf16_f32 v59, v62, v63
  v_mfma_f32_16x16x32_bf16 v[124:127], a[252:255], v[52:55], v[124:127]
  v_smfmac_f32_16x16x64_bf16 a[192:195], a[216:219], v[52:59], v7
  v_mfma_f32_16x16x32_bf16 v[96:99], a[128:131], v[56:59], v[96:99]
  s_xor_b32 s40, s34, 16384
  v_mfma_f32_16x16x32_bf16 v[100:103], a[132:135], v[56:59], v[100:103]
  v_accvgpr_read_b32 v14, a194
  v_accvgpr_read_b32 v15, a195
  v_mfma_f32_16x16x32_bf16 v[104:107], a[136:139], v[56:59], v[104:107]
  v_add_f32 v14, v14, v15
  v_cmp_nge_f32 s[50:51], s37, v14
  v_mfma_f32_16x16x32_bf16 v[108:111], a[140:143], v[56:59], v[108:111]
  v_rcp_f32 v14, v14
  v_mfma_f32_16x16x32_bf16 v[112:115], a[144:147], v[56:59], v[112:115]
  v_mul_f32 v96, v96, v14
  v_mul_f32 v97, v97, v14
  v_mfma_f32_16x16x32_bf16 v[116:119], a[148:151], v[56:59], v[116:119]
  v_mul_f32 v98, v98, v14
  v_mul_f32 v99, v99, v14
  v_mul_f32 v100, v100, v14
  v_mfma_f32_16x16x32_bf16 v[120:123], a[152:155], v[56:59], v[120:123]
  v_mul_f32 v101, v101, v14
  v_mul_f32 v102, v102, v14
  v_mul_f32 v103, v103, v14
  v_cvt_pk_bf16_f32 v96, v96, v97
  v_cvt_pk_bf16_f32 v97, v98, v99
  v_cvt_pk_bf16_f32 v100, v100, v101
  v_cvt_pk_bf16_f32 v101, v102, v103
  v_mfma_f32_16x16x32_bf16 v[124:127], a[156:159], v[56:59], v[124:127]
  ds_write2_b64 v3, v[96:97], v[100:101] offset0:0 offset1:4
  v_pk_mul_f32 v[104:105], v[104:105], v[14:15] op_sel_hi:[1,0]
  v_pk_mul_f32 v[106:107], v[106:107], v[14:15] op_sel_hi:[1,0]
  v_pk_mul_f32 v[108:109], v[108:109], v[14:15] op_sel_hi:[1,0]
  v_pk_mul_f32 v[110:111], v[110:111], v[14:15] op_sel_hi:[1,0]
  v_cvt_pk_bf16_f32 v104, v104, v105
  v_cvt_pk_bf16_f32 v105, v106, v107
  v_cvt_pk_bf16_f32 v108, v108, v109
  v_cvt_pk_bf16_f32 v109, v110, v111
  ds_write2_b64 v3, v[104:105], v[108:109] offset0:8 offset1:12
  v_pk_mul_f32 v[112:113], v[112:113], v[14:15] op_sel_hi:[1,0]
  v_pk_mul_f32 v[114:115], v[114:115], v[14:15] op_sel_hi:[1,0]
  v_pk_mul_f32 v[116:117], v[116:117], v[14:15] op_sel_hi:[1,0]
  v_pk_mul_f32 v[118:119], v[118:119], v[14:15] op_sel_hi:[1,0]
  v_cvt_pk_bf16_f32 v112, v112, v113
  v_cvt_pk_bf16_f32 v113, v114, v115
  v_cvt_pk_bf16_f32 v116, v116, v117
  v_cvt_pk_bf16_f32 v117, v118, v119
  ds_write2_b64 v3, v[112:113], v[116:117] offset0:16 offset1:20
  v_pk_mul_f32 v[120:121], v[120:121], v[14:15] op_sel_hi:[1,0]
  v_pk_mul_f32 v[122:123], v[122:123], v[14:15] op_sel_hi:[1,0]
  v_pk_mul_f32 v[124:125], v[124:125], v[14:15] op_sel_hi:[1,0]
  v_pk_mul_f32 v[126:127], v[126:127], v[14:15] op_sel_hi:[1,0]
  v_cvt_pk_bf16_f32 v120, v120, v121
  v_cvt_pk_bf16_f32 v121, v122, v123
  v_cvt_pk_bf16_f32 v124, v124, v125
  v_cvt_pk_bf16_f32 v125, v126, v127
  s_nop 2
  ds_write2_b64 v3, v[120:121], v[124:125] offset0:24 offset1:28
  ds_read_b128 a[176:179], v0 offset:4352
  ds_read_b128 a[180:183], v0 offset:5440
  ds_read_b128 a[184:187], v0 offset:6528
  ds_read_b128 a[188:191], v0 offset:7616
  s_waitcnt lgkmcnt(3)
  buffer_store_dwordx4 a[176:179], v1, s[28:31], s40 offen sc1
  s_waitcnt lgkmcnt(2)
  buffer_store_dwordx4 a[180:183], v1, s[28:31], s40 offen offset:1024 sc1
  s_waitcnt lgkmcnt(1)
  buffer_store_dwordx4 a[184:187], v1, s[28:31], s40 offen offset:2048 sc1
  s_waitcnt lgkmcnt(0)
  buffer_store_dwordx4 a[188:191], v1, s[28:31], s40 offen offset:3072 sc1
  s_or_b64 s[48:49], s[48:49], s[50:51]
  s_or_b64 s[48:49], s[48:49], s[52:53]
  s_or_b64 s[48:49], s[48:49], s[54:55]
  s_or_b64 s[48:49], s[48:49], s[56:57]
  s_or_b64 s[48:49], s[48:49], s[58:59]
  s_cbranch_scc1 L_fallback
L_done:
L_end:
  s_endpgm
L_alt1:
  s_add_u32 m0, s32, 0
  s_xor_b32 s35, s33, 0
  buffer_load_dwordx4 v0, s[24:27], s35 offen offset:2048 nt lds
  buffer_load_dwordx4 v1, s[24:27], s35 offen offset:3072 nt lds
  s_lshr_b32 s98, s2, 3
  s_lshl_b32 s98, s98, 2
  s_add_u32 s98, s98, s3
  s_lshl_b32 s98, s98, 8
  s_mov_b32 s36, 0x3e0293ee
  s_mov_b32 s37, 0x53800000
  s_mov_b32 s38, 0xffff0000
  v_and_b32 v251, 15, v255
  v_lshrrev_b32 v252, 3, v251
  v_lshlrev_b32 v4, 12, v252
  v_lshlrev_b32 v252, 1, v252
  v_xor_b32 v252, v252, v250
  v_lshl_add_u32 v4, v252, 4, v4
  v_bfe_u32 v252, v255, 2, 1
  v_lshl_add_u32 v4, v252, 10, v4
  v_lshl_add_u32 v4, v248, 6, v4
  v_lshlrev_b32 v3, 10, v249
  v_lshl_add_u32 v3, v248, 6, v3
  v_lshl_add_u32 v3, v250, 4, v3
  v_add_u32 v3, s32, v3
  v_lshrrev_b32 v252, 5, v255
  v_lshlrev_b32 v5, 12, v252
  v_bfe_u32 v252, v255, 4, 1
  v_mul_u32_u24 v252, 1056, v252
  v_add_u32 v5, v5, v252
  v_lshl_add_u32 v5, v249, 6, v5
  v_lshl_add_u32 v5, v248, 3, v5
  v_xor_b32 v6, 32, v5
  s_mul_i32 s41, s3, 8704
  s_add_u32 s41, s41, 32768
  v_mul_u32_u24 v252, 272, v251
  v_lshl_add_u32 v252, v250, 3, v252
  v_add_u32 v252, s41, v252
  v_accvgpr_write_b32 a210, v252
  v_add_u32 v252, 4352, v252
  v_accvgpr_write_b32 a211, v252
  v_mul_u32_u24 v252, 272, v250
  v_lshl_add_u32 v252, v251, 4, v252
  v_add_u32 v252, s41, v252
  v_accvgpr_write_b32 a208, v252
  v_lshlrev_b32 v252, 4, v255
  v_accvgpr_write_b32 a209, v252
  v_lshlrev_b32 v252, 8, v251
  v_bfe_u32 v246, v255, 4, 1
  v_lshl_add_u32 v252, v246, 5, v252
  v_lshrrev_b32 v246, 5, v255
  v_lshl_add_u32 v252, v246, 4, v252
  v_accvgpr_write_b32 a220, v252
  v_lshrrev_b32 v252, 5, v255
  v_bfe_u32 v253, v255, 1, 1
  v_cmp_eq_u32 vcc, v252, v253
  v_mov_b32 v252, 0x3f803f80
  v_and_b32 v253, 1, v255
  v_cndmask_b32 v252, 0, v252, vcc
  v_mul_u32_u24 v253, 0xaaaa, v253
  v_add_u32 v7, 0x4444, v253
  v_lshl_or_b32 v7, v7, 16, v7
  v_accvgpr_write_b32 a192, 0
  v_accvgpr_write_b32 a193, 0
  v_accvgpr_write_b32 a194, 0
  v_accvgpr_write_b32 a195, 0
  v_accvgpr_write_b32 a196, 0
  v_accvgpr_write_b32 a197, 0
  v_accvgpr_write_b32 a198, 0
  v_accvgpr_write_b32 a199, 0
  v_accvgpr_write_b32 a200, 0
  v_accvgpr_write_b32 a201, 0
  v_accvgpr_write_b32 a202, 0
  v_accvgpr_write_b32 a203, 0
  v_bfe_u32 v253, v255, 1, 1
  v_mul_u32_u24 v253, 0x3f80, v253
  v_lshl_or_b32 v253, v253, 16, v253
  v_xor_b32 v246, 0x3f803f80, v253
  v_accvgpr_write_b32 a212, v246
  v_accvgpr_write_b32 a216, v253
  v_accvgpr_write_b32 a213, v246
  v_accvgpr_write_b32 a217, v253
  v_accvgpr_write_b32 a214, v246
  v_accvgpr_write_b32 a218, v253
  v_accvgpr_write_b32 a215, v246
  v_accvgpr_write_b32 a219, v253
  v_accvgpr_write_b32 a204, v252
  v_accvgpr_write_b32 a205, v252
  v_accvgpr_write_b32 a206, v252
  v_accvgpr_write_b32 a207, v252
  s_waitcnt vmcnt(11)
  s_add_u32 m0, s32, 98304
  s_xor_b32 s35, s34, 32768
  buffer_load_dwordx4 v0, s[16:19], s35 offen nt lds
  s_waitcnt vmcnt(11)
  buffer_load_dwordx4 v0, s[16:19], s35 offen offset:1024 nt lds
  s_waitcnt vmcnt(11)
  buffer_load_dwordx4 v0, s[16:19], s35 offen offset:2048 nt lds
  s_waitcnt vmcnt(11)
  v_add_u32 v3, 0x10000, v3
  ds_read_b128 v[224:227], v3 offset:0
  ds_read_b128 v[228:231], v3 offset:256
  ds_read_b128 v[232:235], v3 offset:512
  ds_read_b128 v[236:239], v3 offset:768
  s_waitcnt lgkmcnt(0)
  v_lshlrev_b32 v240, 16, v224
  v_and_b32 v241, s38, v224
  v_lshlrev_b32 v242, 16, v225
  v_and_b32 v243, s38, v225
  v_lshlrev_b32 v244, 16, v226
  v_and_b32 v245, s38, v226
  v_lshlrev_b32 v246, 16, v227
  v_and_b32 v247, s38, v227
  v_pk_mul_f32 v[240:241], v[240:241], s[36:37] op_sel_hi:[1,0]
  v_pk_mul_f32 v[242:243], v[242:243], s[36:37] op_sel_hi:[1,0]
  v_pk_mul_f32 v[244:245], v[244:245], s[36:37] op_sel_hi:[1,0]
  v_pk_mul_f32 v[246:247], v[246:247], s[36:37] op_sel_hi:[1,0]
  v_cvt_pk_bf16_f32 v240, v240, v241
  v_cvt_pk_bf16_f32 v242, v242, v243
  v_cvt_pk_bf16_f32 v244, v244, v245
  v_cvt_pk_bf16_f32 v246, v246, v247
  v_accvgpr_write_b32 a0, v240
  v_accvgpr_write_b32 a1, v242
  v_accvgpr_write_b32 a2, v244
  v_accvgpr_write_b32 a3, v246
  v_lshlrev_b32 v240, 16, v228
  v_and_b32 v241, s38, v228
  v_lshlrev_b32 v242, 16, v229
  v_and_b32 v243, s38, v229
  v_lshlrev_b32 v244, 16, v230
  v_and_b32 v245, s38, v230
  v_lshlrev_b32 v246, 16, v231
  v_and_b32 v247, s38, v231
  v_pk_mul_f32 v[240:241], v[240:241], s[36:37] op_sel_hi:[1,0]
  v_pk_mul_f32 v[242:243], v[242:243], s[36:37] op_sel_hi:[1,0]
  v_pk_mul_f32 v[244:245], v[244:245], s[36:37] op_sel_hi:[1,0]
  v_pk_mul_f32 v[246:247], v[246:247], s[36:37] op_sel_hi:[1,0]
  v_cvt_pk_bf16_f32 v240, v240, v241
  v_cvt_pk_bf16_f32 v242, v242, v243
  v_cvt_pk_bf16_f32 v244, v244, v245
  v_cvt_pk_bf16_f32 v246, v246, v247
  v_accvgpr_write_b32 a4, v240
  v_accvgpr_write_b32 a5, v242
  v_accvgpr_write_b32 a6, v244
  v_accvgpr_write_b32 a7, v246
  v_lshlrev_b32 v240, 16, v232
  v_and_b32 v241, s38, v232
  v_lshlrev_b32 v242, 16, v233
  v_and_b32 v243, s38, v233
  v_lshlrev_b32 v244, 16, v234
  v_and_b32 v245, s38, v234
  v_lshlrev_b32 v246, 16, v235
  v_and_b32 v247, s38, v235
  v_pk_mul_f32 v[240:241], v[240:241], s[36:37] op_sel_hi:[1,0]
  v_pk_mul_f32 v[242:243], v[242:243], s[36:37] op_sel_hi:[1,0]
  v_pk_mul_f32 v[244:245], v[244:245], s[36:37] op_sel_hi:[1,0]
  v_pk_mul_f32 v[246:247], v[246:247], s[36:37] op_sel_hi:[1,0]
  v_cvt_pk_bf16_f32 v240, v240, v241
  v_cvt_pk_bf16_f32 v242, v242, v243
  v_cvt_pk_bf16_f32 v244, v244, v245
  v_cvt_pk_bf16_f32 v246, v246, v247
  v_accvgpr_write_b32 a8, v240
  v_accvgpr_write_b32 a9, v242
  v_accvgpr_write_b32 a10, v244
  v_accvgpr_write_b32 a11, v246
  v_lshlrev_b32 v240, 16, v236
  v_and_b32 v241, s38, v236
  v_lshlrev_b32 v242, 16, v237
  v_and_b32 v243, s38, v237
  v_lshlrev_b32 v244, 16, v238
  v_and_b32 v245, s38, v238
  v_lshlrev_b32 v246, 16, v239
  v_and_b32 v247, s38, v239
  v_pk_mul_f32 v[240:241], v[240:241], s[36:37] op_sel_hi:[1,0]
  v_pk_mul_f32 v[242:243], v[242:243], s[36:37] op_sel_hi:[1,0]
  v_pk_mul_f32 v[244:245], v[244:245], s[36:37] op_sel_hi:[1,0]
  v_pk_mul_f32 v[246:247], v[246:247], s[36:37] op_sel_hi:[1,0]
  v_cvt_pk_bf16_f32 v240, v240, v241
  v_cvt_pk_bf16_f32 v242, v242, v243
  v_cvt_pk_bf16_f32 v244, v244, v245
  v_cvt_pk_bf16_f32 v246, v246, v247
  v_accvgpr_write_b32 a12, v240
  v_accvgpr_write_b32 a13, v242
  v_accvgpr_write_b32 a14, v244
  v_accvgpr_write_b32 a15, v246
  s_nop 1
  s_mov_b64 exec, 0
  s_cmp_eq_u32 s3, 0
  s_cbranch_scc1 L_isl1
  s_cmp_eq_u32 s3, 1
  s_cbranch_scc1 L_isl2
  s_cmp_eq_u32 s3, 2
  s_cbranch_scc1 L_isl3
  s_cmp_eq_u32 s3, 3
  s_cbranch_scc1 L_isl4
L_retAx1:
  s_mov_b64 exec, -1
  s_waitcnt vmcnt(10)
  buffer_load_dwordx4 v0, s[16:19], s35 offen offset:3072 nt lds
  s_waitcnt vmcnt(10)
  s_barrier
  ds_read_b128 a[96:99], v4 offset:0
  ds_read_b128 a[100:103], v4 offset:256
  ds_read_b128 a[104:107], v4 offset:512
  ds_read_b128 a[108:111], v4 offset:768
  ds_read_b128 a[112:115], v4 offset:8192
  ds_read_b128 a[116:119], v4 offset:8448
  ds_read_b128 a[120:123], v4 offset:8704
  ds_read_b128 a[124:127], v4 offset:8960
  s_waitcnt lgkmcnt(7)
  v_mfma_f32_16x16x32_bf16 v[36:39], a[96:99], a[0:3], 0
  s_waitcnt lgkmcnt(6)
  v_mfma_f32_16x16x32_bf16 v[36:39], a[100:103], a[4:7], v[36:39]
  s_waitcnt lgkmcnt(5)
  v_mfma_f32_16x16x32_bf16 v[36:39], a[104:107], a[8:11], v[36:39]
  s_waitcnt lgkmcnt(4)
  v_mfma_f32_16x16x32_bf16 v[36:39], a[108:111], a[12:15], v[36:39]
  s_waitcnt lgkmcnt(3)
  v_mfma_f32_16x16x32_bf16 v[32:35], a[112:115], a[0:3], 0
  s_waitcnt lgkmcnt(2)
  v_mfma_f32_16x16x32_bf16 v[32:35], a[116:119], a[4:7], v[32:35]
  s_waitcnt lgkmcnt(1)
  v_mfma_f32_16x16x32_bf16 v[32:35], a[120:123], a[8:11], v[32:35]
  s_waitcnt lgkmcnt(0)
  v_mfma_f32_16x16x32_bf16 v[32:35], a[124:127], a[12:15], v[32:35]
  s_nop 7
  v_max3_f32 v8, v36, v37, v38
  v_max3_f32 v8, v39, v32, v8
  v_max3_f32 v8, v33, v34, v8
  v_max_f32 v8, v35, v8
  v_mov_b32 v9, v8
  s_nop 1
  v_permlane16_swap_b32 v8, v9
  v_max_f32 v8, v8, v9
  v_mov_b32 v9, v8
  s_nop 1
  v_permlane32_swap_b32 v8, v9
  v_max_f32 v8, v8, v9
  v_sub_f32 v10, 0, v8
  v_add_f32 v36, v36, v10
  v_add_f32 v37, v37, v10
  v_add_f32 v38, v38, v10
  v_add_f32 v39, v39, v10
  v_add_f32 v32, v32, v10
  v_add_f32 v33, v33, v10
  v_add_f32 v34, v34, v10
  v_add_f32 v35, v35, v10
  v_exp_f32 v36, v36
  v_exp_f32 v37, v37
  v_exp_f32 v38, v38
  v_exp_f32 v39, v39
  v_exp_f32 v32, v32
  s_add_u32 m0, s32, 114688
  s_xor_b32 s35, s34, 49152
  buffer_load_dwordx4 v0, s[16:19], s35 offen nt lds
  v_exp_f32 v33, v33
  v_exp_f32 v34, v34
  v_exp_f32 v35, v35
  v_mov_b32 v11, v10
  v_mov_b32 v12, v10
  v_mov_b32 v13, v10
  v_cvt_pk_bf16_f32 v36, v36, v37
  v_cvt_pk_bf16_f32 v37, v38, v39
  v_cvt_pk_bf16_f32 v38, v32, v33
  v_cvt_pk_bf16_f32 v39, v34, v35
  s_mov_b64 exec, 0
  s_cmp_eq_u32 s3, 0
  s_cbranch_scc1 L_isl5
  s_cmp_eq_u32 s3, 1
  s_cbranch_scc1 L_isl6
L_retBx1:
  s_mov_b64 exec, -1
  s_waitcnt vmcnt(10)
  buffer_load_dwordx4 v0, s[16:19], s35 offen offset:1024 nt lds
  s_waitcnt vmcnt(9)
  buffer_load_dwordx4 v0, s[16:19], s35 offen offset:2048 nt lds
  s_waitcnt vmcnt(9)
  ds_read_b128 v[224:227], v3 offset:16384
  ds_read_b128 v[228:231], v3 offset:16640
  ds_read_b128 v[232:235], v3 offset:16896
  ds_read_b128 v[236:239], v3 offset:17152
  s_waitcnt lgkmcnt(0)
  v_lshlrev_b32 v240, 16, v224
  v_and_b32 v241, s38, v224
  v_lshlrev_b32 v242, 16, v225
  v_and_b32 v243, s38, v225
  v_lshlrev_b32 v244, 16, v226
  v_and_b32 v245, s38, v226
  v_lshlrev_b32 v246, 16, v227
  v_and_b32 v247, s38, v227
  v_pk_mul_f32 v[240:241], v[240:241], s[36:37] op_sel_hi:[1,0]
  v_pk_mul_f32 v[242:243], v[242:243], s[36:37] op_sel_hi:[1,0]
  v_pk_mul_f32 v[244:245], v[244:245], s[36:37] op_sel_hi:[1,0]
  v_pk_mul_f32 v[246:247], v[246:247], s[36:37] op_sel_hi:[1,0]
  v_cvt_pk_bf16_f32 v240, v240, v241
  v_cvt_pk_bf16_f32 v242, v242, v243
  v_cvt_pk_bf16_f32 v244, v244, v245
  v_cvt_pk_bf16_f32 v246, v246, v247
  v_accvgpr_write_b32 a16, v240
  v_accvgpr_write_b32 a17, v242
  v_accvgpr_write_b32 a18, v244
  v_accvgpr_write_b32 a19, v246
  v_lshlrev_b32 v240, 16, v228
  v_and_b32 v241, s38, v228
  v_lshlrev_b32 v242, 16, v229
  v_and_b32 v243, s38, v229
  v_lshlrev_b32 v244, 16, v230
  v_and_b32 v245, s38, v230
  v_lshlrev_b32 v246, 16, v231
  v_and_b32 v247, s38, v231
  v_pk_mul_f32 v[240:241], v[240:241], s[36:37] op_sel_hi:[1,0]
  v_pk_mul_f32 v[242:243], v[242:243], s[36:37] op_sel_hi:[1,0]
  v_pk_mul_f32 v[244:245], v[244:245], s[36:37] op_sel_hi:[1,0]
  v_pk_mul_f32 v[246:247], v[246:247], s[36:37] op_sel_hi:[1,0]
  v_cvt_pk_bf16_f32 v240, v240, v241
  v_cvt_pk_bf16_f32 v242, v242, v243
  v_cvt_pk_bf16_f32 v244, v244, v245
  v_cvt_pk_bf16_f32 v246, v246, v247
  v_accvgpr_write_b32 a20, v240
  v_accvgpr_write_b32 a21, v242
  v_accvgpr_write_b32 a22, v244
  v_accvgpr_write_b32 a23, v246
  v_lshlrev_b32 v240, 16, v232
  v_and_b32 v241, s38, v232
  v_lshlrev_b32 v242, 16, v233
  v_and_b32 v243, s38, v233
  v_lshlrev_b32 v244, 16, v234
  v_and_b32 v245, s38, v234
  v_lshlrev_b32 v246, 16, v235
  v_and_b32 v247, s38, v235
  v_pk_mul_f32 v[240:241], v[240:241], s[36:37] op_sel_hi:[1,0]
  v_pk_mul_f32 v[242:243], v[242:243], s[36:37] op_sel_hi:[1,0]
  v_pk_mul_f32 v[244:245], v[244:245], s[36:37] op_sel_hi:[1,0]
  v_pk_mul_f32 v[246:247], v[246:247], s[36:37] op_sel_hi:[1,0]
  v_cvt_pk_bf16_f32 v240, v240, v241
  v_cvt_pk_bf16_f32 v242, v242, v243
  v_cvt_pk_bf16_f32 v244, v244, v245
  v_cvt_pk_bf16_f32 v246, v246, v247
  v_accvgpr_write_b32 a24, v240
  v_accvgpr_write_b32 a25, v242
  v_accvgpr_write_b32 a26, v244
  v_accvgpr_write_b32 a27, v246
  v_lshlrev_b32 v240, 16, v236
  v_and_b32 v241, s38, v236
  v_lshlrev_b32 v242, 16, v237
  v_and_b32 v243, s38, v237
  v_lshlrev_b32 v244, 16, v238
  v_and_b32 v245, s38, v238
  v_lshlrev_b32 v246, 16, v239
  v_and_b32 v247, s38, v239
  v_pk_mul_f32 v[240:241], v[240:241], s[36:37] op_sel_hi:[1,0]
  v_pk_mul_f32 v[242:243], v[242:243], s[36:37] op_sel_hi:[1,0]
  v_pk_mul_f32 v[244:245], v[244:245], s[36:37] op_sel_hi:[1,0]
  v_pk_mul_f32 v[246:247], v[246:247], s[36:37] op_sel_hi:[1,0]
  v_cvt_pk_bf16_f32 v240, v240, v241
  v_cvt_pk_bf16_f32 v242, v242, v243
  v_cvt_pk_bf16_f32 v244, v244, v245
  v_cvt_pk_bf16_f32 v246, v246, v247
  v_accvgpr_write_b32 a28, v240
  v_accvgpr_write_b32 a29, v242
  v_accvgpr_write_b32 a30, v244
  v_accvgpr_write_b32 a31, v246
  s_nop 1
  v_mfma_f32_16x16x32_bf16 v[40:43], a[96:99], a[16:19], 0
  v_mfma_f32_16x16x32_bf16 v[40:43], a[100:103], a[20:23], v[40:43]
  v_mfma_f32_16x16x32_bf16 v[40:43], a[104:107], a[24:27], v[40:43]
  v_mfma_f32_16x16x32_bf16 v[40:43], a[108:111], a[28:31], v[40:43]
  v_mfma_f32_16x16x32_bf16 v[44:47], a[112:115], a[16:19], 0
  v_mfma_f32_16x16x32_bf16 v[44:47], a[116:119], a[20:23], v[44:47]
  v_mfma_f32_16x16x32_bf16 v[44:47], a[120:123], a[24:27], v[44:47]
  v_mfma_f32_16x16x32_bf16 v[44:47], a[124:127], a[28:31], v[44:47]
  s_nop 7
  v_max3_f32 v8, v40, v41, v42
  v_max3_f32 v8, v43, v44, v8
  v_max3_f32 v8, v45, v46, v8
  v_max_f32 v8, v47, v8
  v_mov_b32 v9, v8
  s_nop 1
  v_permlane16_swap_b32 v8, v9
  v_max_f32 v8, v8, v9
  v_mov_b32 v9, v8
  s_nop 1
  v_permlane32_swap_b32 v8, v9
  v_max_f32 v8, v8, v9
  v_sub_f32 v14, 0, v8
  v_add_f32 v40, v40, v14
  v_add_f32 v41, v41, v14
  v_add_f32 v42, v42, v14
  v_add_f32 v43, v43, v14
  v_add_f32 v44, v44, v14
  v_add_f32 v45, v45, v14
  v_add_f32 v46, v46, v14
  v_add_f32 v47, v47, v14
  v_exp_f32 v40, v40
  v_exp_f32 v41, v41
  v_exp_f32 v42, v42
  v_exp_f32 v43, v43
  v_exp_f32 v44, v44
  v_exp_f32 v45, v45
  v_exp_f32 v46, v46
  v_exp_f32 v47, v47
  v_mov_b32 v15, v14
  v_mov_b32 v16, v14
  v_mov_b32 v17, v14
  v_cvt_pk_bf16_f32 v40, v40, v41
  v_cvt_pk_bf16_f32 v41, v42, v43
  v_cvt_pk_bf16_f32 v42, v44, v45
  v_cvt_pk_bf16_f32 v43, v46, v47
  buffer_load_dwordx4 v0, s[16:19], s35 offen offset:3072 nt lds
  s_waitcnt vmcnt(9)
  s_add_u32 m0, s32, 131072
  s_xor_b32 s35, s34, 65536
  buffer_load_dwordx4 v0, s[16:19], s35 offen nt lds
  s_waitcnt vmcnt(9)
  s_barrier
  ds_read_b64_tr_b16 a[128:129], v5 offset:2048
  ds_read_b64_tr_b16 a[130:131], v5 offset:10240
  ds_read_b64_tr_b16 a[132:133], v6 offset:2048
  ds_read_b64_tr_b16 a[134:135], v6 offset:10240
  ds_read_b64_tr_b16 a[136:137], v5 offset:2304
  ds_read_b64_tr_b16 a[138:139], v5 offset:10496
  ds_read_b64_tr_b16 a[140:141], v6 offset:2304
  ds_read_b64_tr_b16 a[142:143], v6 offset:10496
  ds_read_b64_tr_b16 a[144:145], v5 offset:2560
  ds_read_b64_tr_b16 a[146:147], v5 offset:10752
  ds_read_b64_tr_b16 a[148:149], v6 offset:2560
  ds_read_b64_tr_b16 a[150:151], v6 offset:10752
  ds_read_b64_tr_b16 a[152:153], v5 offset:2816
  ds_read_b64_tr_b16 a[154:155], v5 offset:11008
  ds_read_b64_tr_b16 a[156:157], v6 offset:2816
  ds_read_b64_tr_b16 a[158:159], v6 offset:11008
  s_waitcnt lgkmcnt(14)
  v_mfma_f32_16x16x32_bf16 v[64:67], a[128:131], v[36:39], 0
  s_waitcnt lgkmcnt(12)
  v_mfma_f32_16x16x32_bf16 v[68:71], a[132:135], v[36:39], 0
  s_waitcnt lgkmcnt(10)
  v_mfma_f32_16x16x32_bf16 v[72:75], a[136:139], v[36:39], 0
  s_waitcnt lgkmcnt(8)
  v_mfma_f32_16x16x32_bf16 v[76:79], a[140:143], v[36:39], 0
  s_waitcnt lgkmcnt(6)
  v_mfma_f32_16x16x32_bf16 v[80:83], a[144:147], v[36:39], 0
  s_waitcnt lgkmcnt(4)
  v_mfma_f32_16x16x32_bf16 v[84:87], a[148:151], v[36:39], 0
  s_waitcnt lgkmcnt(2)
  v_mfma_f32_16x16x32_bf16 v[88:91], a[152:155], v[36:39], 0
  s_waitcnt lgkmcnt(0)
  v_mfma_f32_16x16x32_bf16 v[92:95], a[156:159], v[36:39], 0
  s_waitcnt vmcnt(8)
  buffer_load_dwordx4 v0, s[16:19], s35 offen offset:1024 nt lds
  s_waitcnt vmcnt(8)
  buffer_load_dwordx4 v0, s[16:19], s35 offen offset:2048 nt lds
  s_waitcnt vmcnt(8)
  buffer_load_dwordx4 v0, s[16:19], s35 offen offset:3072 nt lds
  s_waitcnt vmcnt(8)
  ds_read_b128 v[224:227], v3 offset:32768
  ds_read_b128 v[228:231], v3 offset:33024
  ds_read_b128 v[232:235], v3 offset:33280
  ds_read_b128 v[236:239], v3 offset:33536
  v_smfmac_f32_16x16x64_bf16 a[192:195], a[204:207], v[36:43], v7
  v_mfma_f32_16x16x32_bf16 v[96:99], a[128:131], v[40:43], 0
  v_mfma_f32_16x16x32_bf16 v[100:103], a[132:135], v[40:43], 0
  v_mfma_f32_16x16x32_bf16 v[104:107], a[136:139], v[40:43], 0
  v_mfma_f32_16x16x32_bf16 v[108:111], a[140:143], v[40:43], 0
  v_mfma_f32_16x16x32_bf16 v[112:115], a[144:147], v[40:43], 0
  v_mfma_f32_16x16x32_bf16 v[116:119], a[148:151], v[40:43], 0
  v_mfma_f32_16x16x32_bf16 v[120:123], a[152:155], v[40:43], 0
  v_mfma_f32_16x16x32_bf16 v[124:127], a[156:159], v[40:43], 0
  s_waitcnt lgkmcnt(0)
  v_lshlrev_b32 v240, 16, v224
  v_and_b32 v241, s38, v224
  v_lshlrev_b32 v242, 16, v225
  v_and_b32 v243, s38, v225
  v_lshlrev_b32 v244, 16, v226
  v_and_b32 v245, s38, v226
  v_lshlrev_b32 v246, 16, v227
  v_and_b32 v247, s38, v227
  v_pk_mul_f32 v[240:241], v[240:241], s[36:37] op_sel_hi:[1,0]
  v_pk_mul_f32 v[242:243], v[242:243], s[36:37] op_sel_hi:[1,0]
  v_pk_mul_f32 v[244:245], v[244:245], s[36:37] op_sel_hi:[1,0]
  v_pk_mul_f32 v[246:247], v[246:247], s[36:37] op_sel_hi:[1,0]
  v_cvt_pk_bf16_f32 v240, v240, v241
  v_cvt_pk_bf16_f32 v242, v242, v243
  v_cvt_pk_bf16_f32 v244, v244, v245
  v_cvt_pk_bf16_f32 v246, v246, v247
  v_accvgpr_write_b32 a32, v240
  v_accvgpr_write_b32 a33, v242
  v_accvgpr_write_b32 a34, v244
  v_accvgpr_write_b32 a35, v246
  v_lshlrev_b32 v240, 16, v228
  v_and_b32 v241, s38, v228
  v_lshlrev_b32 v242, 16, v229
  v_and_b32 v243, s38, v229
  v_lshlrev_b32 v244, 16, v230
  v_and_b32 v245, s38, v230
  v_lshlrev_b32 v246, 16, v231
  v_and_b32 v247, s38, v231
  v_pk_mul_f32 v[240:241], v[240:241], s[36:37] op_sel_hi:[1,0]
  v_pk_mul_f32 v[242:243], v[242:243], s[36:37] op_sel_hi:[1,0]
  v_pk_mul_f32 v[244:245], v[244:245], s[36:37] op_sel_hi:[1,0]
  v_pk_mul_f32 v[246:247], v[246:247], s[36:37] op_sel_hi:[1,0]
  v_cvt_pk_bf16_f32 v240, v240, v241
  v_cvt_pk_bf16_f32 v242, v242, v243
  v_cvt_pk_bf16_f32 v244, v244, v245
  v_cvt_pk_bf16_f32 v246, v246, v247
  v_accvgpr_write_b32 a36, v240
  v_accvgpr_write_b32 a37, v242
  v_accvgpr_write_b32 a38, v244
  v_accvgpr_write_b32 a39, v246
  v_lshlrev_b32 v240, 16, v232
  v_and_b32 v241, s38, v232
  v_lshlrev_b32 v242, 16, v233
  v_and_b32 v243, s38, v233
  v_lshlrev_b32 v244, 16, v234
  v_and_b32 v245, s38, v234
  v_lshlrev_b32 v246, 16, v235
  s_add_u32 m0, s32, 147456
  s_xor_b32 s35, s34, 81920
  buffer_load_dwordx4 v0, s[16:19], s35 offen nt lds
  v_and_b32 v247, s38, v235
  v_pk_mul_f32 v[240:241], v[240:241], s[36:37] op_sel_hi:[1,0]
  v_pk_mul_f32 v[242:243], v[242:243], s[36:37] op_sel_hi:[1,0]
  v_pk_mul_f32 v[244:245], v[244:245], s[36:37] op_sel_hi:[1,0]
  v_pk_mul_f32 v[246:247], v[246:247], s[36:37] op_sel_hi:[1,0]
  v_cvt_pk_bf16_f32 v240, v240, v241
  v_cvt_pk_bf16_f32 v242, v242, v243
  v_cvt_pk_bf16_f32 v244, v244, v245
  v_cvt_pk_bf16_f32 v246, v246, v247
  v_accvgpr_write_b32 a40, v240
  v_accvgpr_write_b32 a41, v242
  v_accvgpr_write_b32 a42, v244
  v_accvgpr_write_b32 a43, v246
  v_lshlrev_b32 v240, 16, v236
  v_and_b32 v241, s38, v236
  v_lshlrev_b32 v242, 16, v237
  v_and_b32 v243, s38, v237
  v_lshlrev_b32 v244, 16, v238
  v_and_b32 v245, s38, v238
  v_lshlrev_b32 v246, 16, v239
  v_and_b32 v247, s38, v239
  v_pk_mul_f32 v[240:241], v[240:241], s[36:37] op_sel_hi:[1,0]
  v_pk_mul_f32 v[242:243], v[242:243], s[36:37] op_sel_hi:[1,0]
  v_pk_mul_f32 v[244:245], v[244:245], s[36:37] op_sel_hi:[1,0]
  v_pk_mul_f32 v[246:247], v[246:247], s[36:37] op_sel_hi:[1,0]
  v_cvt_pk_bf16_f32 v240, v240, v241
  v_cvt_pk_bf16_f32 v242, v242, v243
  v_cvt_pk_bf16_f32 v244, v244, v245
  v_cvt_pk_bf16_f32 v246, v246, v247
  v_accvgpr_write_b32 a44, v240
  v_accvgpr_write_b32 a45, v242
  v_accvgpr_write_b32 a46, v244
  v_accvgpr_write_b32 a47, v246
  s_nop 1
  v_mfma_f32_16x16x32_bf16 v[52:55], a[96:99], a[32:35], 0
  v_mfma_f32_16x16x32_bf16 v[52:55], a[100:103], a[36:39], v[52:55]
  v_mfma_f32_16x16x32_bf16 v[52:55], a[104:107], a[40:43], v[52:55]
  v_mfma_f32_16x16x32_bf16 v[52:55], a[108:111], a[44:47], v[52:55]
  v_mfma_f32_16x16x32_bf16 v[48:51], a[112:115], a[32:35], 0
  v_mfma_f32_16x16x32_bf16 v[48:51], a[116:119], a[36:39], v[48:51]
  v_mfma_f32_16x16x32_bf16 v[48:51], a[120:123], a[40:43], v[48:51]
  v_mfma_f32_16x16x32_bf16 v[48:51], a[124:127], a[44:47], v[48:51]
  s_nop 7
  v_max3_f32 v8, v52, v53, v54
  v_max3_f32 v8, v55, v48, v8
  v_max3_f32 v8, v49, v50, v8
  v_max_f32 v8, v51, v8
  v_mov_b32 v9, v8
  s_nop 1
  v_permlane16_swap_b32 v8, v9
  v_max_f32 v8, v8, v9
  v_mov_b32 v9, v8
  s_nop 1
  v_permlane32_swap_b32 v8, v9
  v_max_f32 v8, v8, v9
  v_sub_f32 v18, 0, v8
  v_add_f32 v52, v52, v18
  v_add_f32 v53, v53, v18
  v_add_f32 v54, v54, v18
  v_add_f32 v55, v55, v18
  v_add_f32 v48, v48, v18
  v_add_f32 v49, v49, v18
  v_add_f32 v50, v50, v18
  v_add_f32 v51, v51, v18
  v_exp_f32 v52, v52
  v_exp_f32 v53, v53
  v_exp_f32 v54, v54
  v_exp_f32 v55, v55
  v_exp_f32 v48, v48
  v_exp_f32 v49, v49
  v_exp_f32 v50, v50
  v_exp_f32 v51, v51
  v_mov_b32 v19, v18
  v_mov_b32 v20, v18
  v_mov_b32 v21, v18
  v_cvt_pk_bf16_f32 v52, v52, v53
  v_cvt_pk_bf16_f32 v53, v54, v55
  v_cvt_pk_bf16_f32 v54, v48, v49
  v_cvt_pk_bf16_f32 v55, v50, v51
  s_waitcnt vmcnt(7)
  buffer_load_dwordx4 v0, s[16:19], s35 offen offset:1024 nt lds
  s_waitcnt vmcnt(7)
  buffer_load_dwordx4 v0, s[16:19], s35 offen offset:2048 nt lds
  s_waitcnt vmcnt(7)
  ds_read_b128 v[224:227], v3 offset:49152
  ds_read_b128 v[228:231], v3 offset:49408
  ds_read_b128 v[232:235], v3 offset:49664
  ds_read_b128 v[236:239], v3 offset:49920
  v_mfma_f32_16x16x32_bf16 v[128:131], a[128:131], v[52:55], 0
  v_mfma_f32_16x16x32_bf16 v[132:135], a[132:135], v[52:55], 0
  v_mfma_f32_16x16x32_bf16 v[136:139], a[136:139], v[52:55], 0
  v_mfma_f32_16x16x32_bf16 v[140:143], a[140:143], v[52:55], 0
  v_mfma_f32_16x16x32_bf16 v[144:147], a[144:147], v[52:55], 0
  v_mfma_f32_16x16x32_bf16 v[148:151], a[148:151], v[52:55], 0
  v_mfma_f32_16x16x32_bf16 v[152:155], a[152:155], v[52:55], 0
  v_mfma_f32_16x16x32_bf16 v[156:159], a[156:159], v[52:55], 0
  s_waitcnt lgkmcnt(0)
  v_lshlrev_b32 v240, 16, v224
  v_and_b32 v241, s38, v224
  v_lshlrev_b32 v242, 16, v225
  v_and_b32 v243, s38, v225
  v_lshlrev_b32 v244, 16, v226
  v_and_b32 v245, s38, v226
  v_lshlrev_b32 v246, 16, v227
  v_and_b32 v247, s38, v227
  v_pk_mul_f32 v[240:241], v[240:241], s[36:37] op_sel_hi:[1,0]
  v_pk_mul_f32 v[242:243], v[242:243], s[36:37] op_sel_hi:[1,0]
  v_pk_mul_f32 v[244:245], v[244:245], s[36:37] op_sel_hi:[1,0]
  v_pk_mul_f32 v[246:247], v[246:247], s[36:37] op_sel_hi:[1,0]
  v_cvt_pk_bf16_f32 v240, v240, v241
  v_cvt_pk_bf16_f32 v242, v242, v243
  v_cvt_pk_bf16_f32 v244, v244, v245
  v_cvt_pk_bf16_f32 v246, v246, v247
  v_accvgpr_write_b32 a48, v240
  v_accvgpr_write_b32 a49, v242
  v_accvgpr_write_b32 a50, v244
  v_accvgpr_write_b32 a51, v246
  v_lshlrev_b32 v240, 16, v228
  v_and_b32 v241, s38, v228
  v_lshlrev_b32 v242, 16, v229
  v_and_b32 v243, s38, v229
  v_lshlrev_b32 v244, 16, v230
  v_and_b32 v245, s38, v230
  v_lshlrev_b32 v246, 16, v231
  v_and_b32 v247, s38, v231
  v_pk_mul_f32 v[240:241], v[240:241], s[36:37] op_sel_hi:[1,0]
  v_pk_mul_f32 v[242:243], v[242:243], s[36:37] op_sel_hi:[1,0]
  v_pk_mul_f32 v[244:245], v[244:245], s[36:37] op_sel_hi:[1,0]
  v_pk_mul_f32 v[246:247], v[246:247], s[36:37] op_sel_hi:[1,0]
  v_cvt_pk_bf16_f32 v240, v240, v241
  v_cvt_pk_bf16_f32 v242, v242, v243
  v_cvt_pk_bf16_f32 v244, v244, v245
  v_cvt_pk_bf16_f32 v246, v246, v247
  v_accvgpr_write_b32 a52, v240
  v_accvgpr_write_b32 a53, v242
  v_accvgpr_write_b32 a54, v244
  v_accvgpr_write_b32 a55, v246
  v_lshlrev_b32 v240, 16, v232
  v_and_b32 v241, s38, v232
  v_lshlrev_b32 v242, 16, v233
  v_and_b32 v243, s38, v233
  v_lshlrev_b32 v244, 16, v234
  v_and_b32 v245, s38, v234
  v_lshlrev_b32 v246, 16, v235
  v_and_b32 v247, s38, v235
  v_pk_mul_f32 v[240:241], v[240:241], s[36:37] op_sel_hi:[1,0]
  v_pk_mul_f32 v[242:243], v[242:243], s[36:37] op_sel_hi:[1,0]
  v_pk_mul_f32 v[244:245], v[244:245], s[36:37] op_sel_hi:[1,0]
  buffer_load_dwordx4 v0, s[16:19], s35 offen offset:3072 nt lds
  v_pk_mul_f32 v[246:247], v[246:247], s[36:37] op_sel_hi:[1,0]
  v_cvt_pk_bf16_f32 v240, v240, v241
  v_cvt_pk_bf16_f32 v242, v242, v243
  v_cvt_pk_bf16_f32 v244, v244, v245
  v_cvt_pk_bf16_f32 v246, v246, v247
  v_accvgpr_write_b32 a56, v240
  v_accvgpr_write_b32 a57, v242
  v_accvgpr_write_b32 a58, v244
  v_accvgpr_write_b32 a59, v246
  v_lshlrev_b32 v240, 16, v236
  v_and_b32 v241, s38, v236
  v_lshlrev_b32 v242, 16, v237
  v_and_b32 v243, s38, v237
  v_lshlrev_b32 v244, 16, v238
  v_and_b32 v245, s38, v238
  v_lshlrev_b32 v246, 16, v239
  v_and_b32 v247, s38, v239
  v_pk_mul_f32 v[240:241], v[240:241], s[36:37] op_sel_hi:[1,0]
  v_pk_mul_f32 v[242:243], v[242:243], s[36:37] op_sel_hi:[1,0]
  v_pk_mul_f32 v[244:245], v[244:245], s[36:37] op_sel_hi:[1,0]
  v_pk_mul_f32 v[246:247], v[246:247], s[36:37] op_sel_hi:[1,0]
  v_cvt_pk_bf16_f32 v240, v240, v241
  v_cvt_pk_bf16_f32 v242, v242, v243
  v_cvt_pk_bf16_f32 v244, v244, v245
  v_cvt_pk_bf16_f32 v246, v246, v247
  v_accvgpr_write_b32 a60, v240
  v_accvgpr_write_b32 a61, v242
  v_accvgpr_write_b32 a62, v244
  v_accvgpr_write_b32 a63, v246
  s_nop 1
  v_mfma_f32_16x16x32_bf16 v[56:59], a[96:99], a[48:51], 0
  v_mfma_f32_16x16x32_bf16 v[56:59], a[100:103], a[52:55], v[56:59]
  v_mfma_f32_16x16x32_bf16 v[56:59], a[104:107], a[56:59], v[56:59]
  v_mfma_f32_16x16x32_bf16 v[56:59], a[108:111], a[60:63], v[56:59]
  v_mfma_f32_16x16x32_bf16 v[60:63], a[112:115], a[48:51], 0
  v_mfma_f32_16x16x32_bf16 v[60:63], a[116:119], a[52:55], v[60:63]
  v_mfma_f32_16x16x32_bf16 v[60:63], a[120:123], a[56:59], v[60:63]
  v_mfma_f32_16x16x32_bf16 v[60:63], a[124:127], a[60:63], v[60:63]
  s_nop 7
  v_max3_f32 v8, v56, v57, v58
  v_max3_f32 v8, v59, v60, v8
  v_max3_f32 v8, v61, v62, v8
  v_max_f32 v8, v63, v8
  v_mov_b32 v9, v8
  s_nop 1
  v_permlane16_swap_b32 v8, v9
  v_max_f32 v8, v8, v9
  v_mov_b32 v9, v8
  s_nop 1
  v_permlane32_swap_b32 v8, v9
  v_max_f32 v8, v8, v9
  v_sub_f32 v22, 0, v8
  v_add_f32 v56, v56, v22
  v_add_f32 v57, v57, v22
  v_add_f32 v58, v58, v22
  v_add_f32 v59, v59, v22
  v_add_f32 v60, v60, v22
  v_add_f32 v61, v61, v22
  v_add_f32 v62, v62, v22
  v_add_f32 v63, v63, v22
  v_exp_f32 v56, v56
  v_exp_f32 v57, v57
  v_exp_f32 v58, v58
  v_exp_f32 v59, v59
  v_exp_f32 v60, v60
  v_exp_f32 v61, v61
  v_exp_f32 v62, v62
  v_exp_f32 v63, v63
  v_mov_b32 v23, v22
  v_mov_b32 v24, v22
  v_mov_b32 v25, v22
  v_cvt_pk_bf16_f32 v56, v56, v57
  v_cvt_pk_bf16_f32 v57, v58, v59
  v_cvt_pk_bf16_f32 v58, v60, v61
  v_cvt_pk_bf16_f32 v59, v62, v63
  s_waitcnt vmcnt(6)
  s_add_u32 m0, s32, 16384
  s_xor_b32 s35, s33, 8192
  buffer_load_dwordx4 v2, s[20:23], s35 offen nt lds
  s_waitcnt vmcnt(6)
  buffer_load_dwordx4 v2, s[20:23], s35 offen offset:1024 nt lds
  s_waitcnt vmcnt(6)
  v_add_u32 v3, 0x10000, v3
  ds_read_b128 v[224:227], v3 offset:0
  ds_read_b128 v[228:231], v3 offset:256
  ds_read_b128 v[232:235], v3 offset:512
  ds_read_b128 v[236:239], v3 offset:768
  v_smfmac_f32_16x16x64_bf16 a[196:199], a[204:207], v[52:59], v7
  v_mfma_f32_16x16x32_bf16 v[160:163], a[128:131], v[56:59], 0
  v_mfma_f32_16x16x32_bf16 v[164:167], a[132:135], v[56:59], 0
  v_mfma_f32_16x16x32_bf16 v[168:171], a[136:139], v[56:59], 0
  v_mfma_f32_16x16x32_bf16 v[172:175], a[140:143], v[56:59], 0
  v_mfma_f32_16x16x32_bf16 v[176:179], a[144:147], v[56:59], 0
  v_mfma_f32_16x16x32_bf16 v[180:183], a[148:151], v[56:59], 0
  v_mfma_f32_16x16x32_bf16 v[184:187], a[152:155], v[56:59], 0
  v_mfma_f32_16x16x32_bf16 v[188:191], a[156:159], v[56:59], 0
  s_waitcnt lgkmcnt(0)
  v_lshlrev_b32 v240, 16, v224
  v_and_b32 v241, s38, v224
  v_lshlrev_b32 v242, 16, v225
  v_and_b32 v243, s38, v225
  v_lshlrev_b32 v244, 16, v226
  v_and_b32 v245, s38, v226
  v_lshlrev_b32 v246, 16, v227
  v_and_b32 v247, s38, v227
  v_pk_mul_f32 v[240:241], v[240:241], s[36:37] op_sel_hi:[1,0]
  v_pk_mul_f32 v[242:243], v[242:243], s[36:37] op_sel_hi:[1,0]
  v_pk_mul_f32 v[244:245], v[244:245], s[36:37] op_sel_hi:[1,0]
  v_pk_mul_f32 v[246:247], v[246:247], s[36:37] op_sel_hi:[1,0]
  v_cvt_pk_bf16_f32 v240, v240, v241
  v_cvt_pk_bf16_f32 v242, v242, v243
  v_cvt_pk_bf16_f32 v244, v244, v245
  v_cvt_pk_bf16_f32 v246, v246, v247
  v_accvgpr_write_b32 a64, v240
  v_accvgpr_write_b32 a65, v242
  v_accvgpr_write_b32 a66, v244
  v_accvgpr_write_b32 a67, v246
  v_lshlrev_b32 v240, 16, v228
  v_and_b32 v241, s38, v228
  v_lshlrev_b32 v242, 16, v229
  v_and_b32 v243, s38, v229
  v_lshlrev_b32 v244, 16, v230
  v_and_b32 v245, s38, v230
  v_lshlrev_b32 v246, 16, v231
  v_and_b32 v247, s38, v231
  v_pk_mul_f32 v[240:241], v[240:241], s[36:37] op_sel_hi:[1,0]
  v_pk_mul_f32 v[242:243], v[242:243], s[36:37] op_sel_hi:[1,0]
  v_pk_mul_f32 v[244:245], v[244:245], s[36:37] op_sel_hi:[1,0]
  v_pk_mul_f32 v[246:247], v[246:247], s[36:37] op_sel_hi:[1,0]
  v_cvt_pk_bf16_f32 v240, v240, v241
  v_cvt_pk_bf16_f32 v242, v242, v243
  v_cvt_pk_bf16_f32 v244, v244, v245
  v_cvt_pk_bf16_f32 v246, v246, v247
  v_accvgpr_write_b32 a68, v240
  v_accvgpr_write_b32 a69, v242
  v_accvgpr_write_b32 a70, v244
  v_accvgpr_write_b32 a71, v246
  v_lshlrev_b32 v240, 16, v232
  v_and_b32 v241, s38, v232
  v_lshlrev_b32 v242, 16, v233
  v_and_b32 v243, s38, v233
  v_lshlrev_b32 v244, 16, v234
  v_and_b32 v245, s38, v234
  buffer_load_dwordx4 v0, s[24:27], s35 offen offset:2048 nt lds
  v_lshlrev_b32 v246, 16, v235
  v_and_b32 v247, s38, v235
  v_pk_mul_f32 v[240:241], v[240:241], s[36:37] op_sel_hi:[1,0]
  v_pk_mul_f32 v[242:243], v[242:243], s[36:37] op_sel_hi:[1,0]
  v_pk_mul_f32 v[244:245], v[244:245], s[36:37] op_sel_hi:[1,0]
  v_pk_mul_f32 v[246:247], v[246:247], s[36:37] op_sel_hi:[1,0]
  v_cvt_pk_bf16_f32 v240, v240, v241
  v_cvt_pk_bf16_f32 v242, v242, v243
  v_cvt_pk_bf16_f32 v244, v244, v245
  v_cvt_pk_bf16_f32 v246, v246, v247
  v_accvgpr_write_b32 a72, v240
  v_accvgpr_write_b32 a73, v242
  v_accvgpr_write_b32 a74, v244
  v_accvgpr_write_b32 a75, v246
  v_lshlrev_b32 v240, 16, v236
  v_and_b32 v241, s38, v236
  v_lshlrev_b32 v242, 16, v237
  v_and_b32 v243, s38, v237
  v_lshlrev_b32 v244, 16, v238
  v_and_b32 v245, s38, v238
  v_lshlrev_b32 v246, 16, v239
  v_and_b32 v247, s38, v239
  v_pk_mul_f32 v[240:241], v[240:241], s[36:37] op_sel_hi:[1,0]
  v_pk_mul_f32 v[242:243], v[242:243], s[36:37] op_sel_hi:[1,0]
  v_pk_mul_f32 v[244:245], v[244:245], s[36:37] op_sel_hi:[1,0]
  v_pk_mul_f32 v[246:247], v[246:247], s[36:37] op_sel_hi:[1,0]
  v_cvt_pk_bf16_f32 v240, v240, v241
  v_cvt_pk_bf16_f32 v242, v242, v243
  v_cvt_pk_bf16_f32 v244, v244, v245
  v_cvt_pk_bf16_f32 v246, v246, v247
  v_accvgpr_write_b32 a76, v240
  v_accvgpr_write_b32 a77, v242
  v_accvgpr_write_b32 a78, v244
  v_accvgpr_write_b32 a79, v246
  s_nop 1
  v_mfma_f32_16x16x32_bf16 v[36:39], a[96:99], a[64:67], 0
  v_mfma_f32_16x16x32_bf16 v[36:39], a[100:103], a[68:71], v[36:39]
  v_mfma_f32_16x16x32_bf16 v[36:39], a[104:107], a[72:75], v[36:39]
  v_mfma_f32_16x16x32_bf16 v[36:39], a[108:111], a[76:79], v[36:39]
  v_mfma_f32_16x16x32_bf16 v[32:35], a[112:115], a[64:67], 0
  v_mfma_f32_16x16x32_bf16 v[32:35], a[116:119], a[68:71], v[32:35]
  v_mfma_f32_16x16x32_bf16 v[32:35], a[120:123], a[72:75], v[32:35]
  v_mfma_f32_16x16x32_bf16 v[32:35], a[124:127], a[76:79], v[32:35]
  s_nop 7
  v_max3_f32 v8, v36, v37, v38
  v_max3_f32 v8, v39, v32, v8
  v_max3_f32 v8, v33, v34, v8
  v_max_f32 v8, v35, v8
  v_mov_b32 v9, v8
  s_nop 1
  v_permlane16_swap_b32 v8, v9
  v_max_f32 v8, v8, v9
  v_mov_b32 v9, v8
  s_nop 1
  v_permlane32_swap_b32 v8, v9
  v_max_f32 v8, v8, v9
  v_sub_f32 v26, 0, v8
  v_add_f32 v36, v36, v26
  v_add_f32 v37, v37, v26
  v_add_f32 v38, v38, v26
  v_add_f32 v39, v39, v26
  v_add_f32 v32, v32, v26
  v_add_f32 v33, v33, v26
  v_add_f32 v34, v34, v26
  v_add_f32 v35, v35, v26
  v_exp_f32 v36, v36
  v_exp_f32 v37, v37
  v_exp_f32 v38, v38
  v_exp_f32 v39, v39
  v_exp_f32 v32, v32
  v_exp_f32 v33, v33
  v_exp_f32 v34, v34
  v_exp_f32 v35, v35
  v_mov_b32 v27, v26
  v_mov_b32 v28, v26
  v_mov_b32 v29, v26
  v_cvt_pk_bf16_f32 v36, v36, v37
  v_cvt_pk_bf16_f32 v37, v38, v39
  v_cvt_pk_bf16_f32 v38, v32, v33
  v_cvt_pk_bf16_f32 v39, v34, v35
  s_waitcnt vmcnt(5)
  buffer_load_dwordx4 v1, s[24:27], s35 offen offset:3072 nt lds
  s_waitcnt vmcnt(4)
  ds_read_b128 a[80:83], v3 offset:16384
  ds_read_b128 a[84:87], v3 offset:16640
  ds_read_b128 a[88:91], v3 offset:16896
  ds_read_b128 a[92:95], v3 offset:17152
  v_mfma_f32_16x16x32_bf16 v[192:195], a[128:131], v[36:39], 0
  v_mfma_f32_16x16x32_bf16 v[196:199], a[132:135], v[36:39], 0
  v_mfma_f32_16x16x32_bf16 v[200:203], a[136:139], v[36:39], 0
  v_mfma_f32_16x16x32_bf16 v[204:207], a[140:143], v[36:39], 0
  v_mfma_f32_16x16x32_bf16 v[208:211], a[144:147], v[36:39], 0
  v_mfma_f32_16x16x32_bf16 v[212:215], a[148:151], v[36:39], 0
  v_mfma_f32_16x16x32_bf16 v[216:219], a[152:155], v[36:39], 0
  v_mfma_f32_16x16x32_bf16 v[220:223], a[156:159], v[36:39], 0
  s_waitcnt lgkmcnt(0)
  s_nop 1
  v_mfma_f32_16x16x32_bf16 v[40:43], a[96:99], a[80:83], 0
  v_mfma_f32_16x16x32_bf16 v[40:43], a[100:103], a[84:87], v[40:43]
  v_mfma_f32_16x16x32_bf16 v[40:43], a[104:107], a[88:91], v[40:43]
  v_mfma_f32_16x16x32_bf16 v[40:43], a[108:111], a[92:95], v[40:43]
  v_mfma_f32_16x16x32_bf16 v[44:47], a[112:115], a[80:83], 0
  v_mfma_f32_16x16x32_bf16 v[44:47], a[116:119], a[84:87], v[44:47]
  v_mfma_f32_16x16x32_bf16 v[44:47], a[120:123], a[88:91], v[44:47]
  v_mfma_f32_16x16x32_bf16 v[44:47], a[124:127], a[92:95], v[44:47]
  s_nop 7
  v_max3_f32 v8, v40, v41, v42
  v_max3_f32 v8, v43, v44, v8
  v_max3_f32 v8, v45, v46, v8
  v_max_f32 v8, v47, v8
  v_mov_b32 v9, v8
  s_nop 1
  v_permlane16_swap_b32 v8, v9
  v_max_f32 v8, v8, v9
  v_mov_b32 v9, v8
  s_nop 1
  v_permlane32_swap_b32 v8, v9
  v_max_f32 v8, v8, v9
  v_mul_f32 v30, s36, -v8
  v_fma_f32 v40, v40, s36, v30
  v_fma_f32 v41, v41, s36, v30
  v_fma_f32 v42, v42, s36, v30
  v_fma_f32 v43, v43, s36, v30
  v_fma_f32 v44, v44, s36, v30
  v_fma_f32 v45, v45, s36, v30
  v_fma_f32 v46, v46, s36, v30
  v_fma_f32 v47, v47, s36, v30
  v_exp_f32 v40, v40
  v_exp_f32 v41, v41
  v_exp_f32 v42, v42
  v_exp_f32 v43, v43
  v_exp_f32 v44, v44
  v_exp_f32 v45, v45
  v_exp_f32 v46, v46
  v_exp_f32 v47, v47
  v_cvt_pk_bf16_f32 v40, v40, v41
  v_cvt_pk_bf16_f32 v41, v42, v43
  v_cvt_pk_bf16_f32 v42, v44, v45
  v_cvt_pk_bf16_f32 v43, v46, v47
  s_branch L_join
L_fallback:
  s_waitcnt vmcnt(0) lgkmcnt(0)
  v_lshrrev_b32 v123, 4, v1
  v_bfe_u32 v115, v123, 2, 2
  v_lshlrev_b32 v124, 8, v115
  v_lshrrev_b32 v115, 4, v123
  v_lshl_add_u32 v124, v115, 6, v124
  v_and_b32 v115, 3, v123
  v_lshl_add_u32 v124, v115, 4, v124
  v_and_b32 v115, 15, v123
  v_lshrrev_b32 v116, 4, v123
  v_lshlrev_b32 v120, 8, v115
  v_lshl_add_u32 v122, v116, 3, v120
  v_lshl_add_u32 v120, v116, 4, v120
  v_lshlrev_b32 v121, 10, v116
  v_bfe_u32 v115, v123, 2, 2
  v_lshl_add_u32 v121, v115, 6, v121
  v_and_b32 v115, 3, v123
  v_lshl_add_u32 v121, v115, 3, v121
  v_add_u32 v121, s41, v121
  s_mov_b32 s48, 0
L_fb_q:
  s_mov_b32 s52, 0
  s_lshl_b32 s50, s48, 14
  s_add_u32 s50, s50, s32
  buffer_load_dwordx4 v[20:23], v120, s[16:19], s50 offen offset:0
  buffer_load_dwordx4 v[24:27], v120, s[16:19], s50 offen offset:64
  buffer_load_dwordx4 v[28:31], v120, s[16:19], s50 offen offset:128
  buffer_load_dwordx4 v[32:35], v120, s[16:19], s50 offen offset:192
  v_mov_b32 v112, 0xff800000
  v_mov_b32 v113, 0
  v_mov_b32 v128, 0
  v_mov_b32 v129, 0
  v_mov_b32 v130, 0
  v_mov_b32 v131, 0
  v_mov_b32 v132, 0
  v_mov_b32 v133, 0
  v_mov_b32 v134, 0
  v_mov_b32 v135, 0
  v_mov_b32 v136, 0
  v_mov_b32 v137, 0
  v_mov_b32 v138, 0
  v_mov_b32 v139, 0
  v_mov_b32 v140, 0
  v_mov_b32 v141, 0
  v_mov_b32 v142, 0
  v_mov_b32 v143, 0
  v_mov_b32 v144, 0
  v_mov_b32 v145, 0
  v_mov_b32 v146, 0
  v_mov_b32 v147, 0
  v_mov_b32 v148, 0
  v_mov_b32 v149, 0
  v_mov_b32 v150, 0
  v_mov_b32 v151, 0
  v_mov_b32 v152, 0
  v_mov_b32 v153, 0
  v_mov_b32 v154, 0
  v_mov_b32 v155, 0
  v_mov_b32 v156, 0
  v_mov_b32 v157, 0
  v_mov_b32 v158, 0
  v_mov_b32 v159, 0
  s_mov_b32 s49, s52
  s_add_u32 s53, s52, 98304
L_fb_t:
  s_add_u32 s51, s49, 4096
  buffer_load_dwordx4 v[36:39], v120, s[20:23], s49 offen offset:0
  buffer_load_dwordx4 v[40:43], v120, s[20:23], s49 offen offset:64
  buffer_load_dwordx4 v[44:47], v120, s[20:23], s49 offen offset:128
  buffer_load_dwordx4 v[48:51], v120, s[20:23], s49 offen offset:192
  buffer_load_dwordx4 v[52:55], v120, s[20:23], s51 offen offset:0
  buffer_load_dwordx4 v[56:59], v120, s[20:23], s51 offen offset:64
  buffer_load_dwordx4 v[60:63], v120, s[20:23], s51 offen offset:128
  buffer_load_dwordx4 v[64:67], v120, s[20:23], s51 offen offset:192
  s_add_u32 m0, s41, 0
  s_add_u32 s51, s49, 2048
  buffer_load_dwordx4 v124, s[24:27], s51 offen offset:0 lds
  buffer_load_dwordx4 v124, s[24:27], s51 offen offset:1024 lds
  buffer_load_dwordx4 v124, s[24:27], s51 offen offset:2048 lds
  buffer_load_dwordx4 v124, s[24:27], s51 offen offset:3072 lds
  s_add_u32 m0, s41, 4096
  s_add_u32 s51, s49, 6144
  buffer_load_dwordx4 v124, s[24:27], s51 offen offset:0 lds
  buffer_load_dwordx4 v124, s[24:27], s51 offen offset:1024 lds
  buffer_load_dwordx4 v124, s[24:27], s51 offen offset:2048 lds
  buffer_load_dwordx4 v124, s[24:27], s51 offen offset:3072 lds
  s_waitcnt vmcnt(0)
  ds_read_b64_tr_b16 v[68:69], v121 offset:0
  ds_read_b64_tr_b16 v[70:71], v121 offset:4096
  ds_read_b64_tr_b16 v[72:73], v121 offset:32
  ds_read_b64_tr_b16 v[74:75], v121 offset:4128
  ds_read_b64_tr_b16 v[76:77], v121 offset:256
  ds_read_b64_tr_b16 v[78:79], v121 offset:4352
  ds_read_b64_tr_b16 v[80:81], v121 offset:288
  ds_read_b64_tr_b16 v[82:83], v121 offset:4384
  ds_read_b64_tr_b16 v[84:85], v121 offset:512
  ds_read_b64_tr_b16 v[86:87], v121 offset:4608
  ds_read_b64_tr_b16 v[88:89], v121 offset:544
  ds_read_b64_tr_b16 v[90:91], v121 offset:4640
  ds_read_b64_tr_b16 v[92:93], v121 offset:768
  ds_read_b64_tr_b16 v[94:95], v121 offset:4864
  ds_read_b64_tr_b16 v[96:97], v121 offset:800
  ds_read_b64_tr_b16 v[98:99], v121 offset:4896
  v_mfma_f32_16x16x32_bf16 v[100:103], v[36:39], v[20:23], 0
  v_mfma_f32_16x16x32_bf16 v[100:103], v[40:43], v[24:27], v[100:103]
  v_mfma_f32_16x16x32_bf16 v[100:103], v[44:47], v[28:31], v[100:103]
  v_mfma_f32_16x16x32_bf16 v[100:103], v[48:51], v[32:35], v[100:103]
  v_mfma_f32_16x16x32_bf16 v[104:107], v[52:55], v[20:23], 0
  v_mfma_f32_16x16x32_bf16 v[104:107], v[56:59], v[24:27], v[104:107]
  v_mfma_f32_16x16x32_bf16 v[104:107], v[60:63], v[28:31], v[104:107]
  v_mfma_f32_16x16x32_bf16 v[104:107], v[64:67], v[32:35], v[104:107]
  s_nop 15
  v_mul_f32 v100, s36, v100
  v_mul_f32 v101, s36, v101
  v_mul_f32 v102, s36, v102
  v_mul_f32 v103, s36, v103
  v_mul_f32 v104, s36, v104
  v_mul_f32 v105, s36, v105
  v_mul_f32 v106, s36, v106
  v_mul_f32 v107, s36, v107
  v_max3_f32 v115, v100, v101, v112
  v_max3_f32 v115, v102, v103, v115
  v_max3_f32 v115, v104, v105, v115
  v_max3_f32 v115, v106, v107, v115
  v_mov_b32 v116, v115
  s_nop 2
  v_permlane16_swap_b32 v115, v116
  s_nop 2
  v_max_f32 v115, v115, v116
  v_mov_b32 v116, v115
  s_nop 2
  v_permlane32_swap_b32 v115, v116
  s_nop 2
  v_max_f32 v115, v115, v116
  v_sub_f32 v114, v112, v115
  v_exp_f32 v114, v114
  v_mov_b32 v112, v115
  v_sub_f32 v100, v100, v112
  v_sub_f32 v101, v101, v112
  v_sub_f32 v102, v102, v112
  v_sub_f32 v103, v103, v112
  v_sub_f32 v104, v104, v112
  v_sub_f32 v105, v105, v112
  v_sub_f32 v106, v106, v112
  v_sub_f32 v107, v107, v112
  v_exp_f32 v100, v100
  v_exp_f32 v101, v101
  v_exp_f32 v102, v102
  v_exp_f32 v103, v103
  v_exp_f32 v104, v104
  v_exp_f32 v105, v105
  v_exp_f32 v106, v106
  v_exp_f32 v107, v107
  v_mul_f32 v113, v113, v114
  v_mul_f32 v128, v128, v114
  v_mul_f32 v129, v129, v114
  v_mul_f32 v130, v130, v114
  v_mul_f32 v131, v131, v114
  v_mul_f32 v132, v132, v114
  v_mul_f32 v133, v133, v114
  v_mul_f32 v134, v134, v114
  v_mul_f32 v135, v135, v114
  v_mul_f32 v136, v136, v114
  v_mul_f32 v137, v137, v114
  v_mul_f32 v138, v138, v114
  v_mul_f32 v139, v139, v114
  v_mul_f32 v140, v140, v114
  v_mul_f32 v141, v141, v114
  v_mul_f32 v142, v142, v114
  v_mul_f32 v143, v143, v114
  v_mul_f32 v144, v144, v114
  v_mul_f32 v145, v145, v114
  v_mul_f32 v146, v146, v114
  v_mul_f32 v147, v147, v114
  v_mul_f32 v148, v148, v114
  v_mul_f32 v149, v149, v114
  v_mul_f32 v150, v150, v114
  v_mul_f32 v151, v151, v114
  v_mul_f32 v152, v152, v114
  v_mul_f32 v153, v153, v114
  v_mul_f32 v154, v154, v114
  v_mul_f32 v155, v155, v114
  v_mul_f32 v156, v156, v114
  v_mul_f32 v157, v157, v114
  v_mul_f32 v158, v158, v114
  v_mul_f32 v159, v159, v114
  v_add_f32 v113, v113, v100
  v_add_f32 v113, v113, v101
  v_add_f32 v113, v113, v102
  v_add_f32 v113, v113, v103
  v_add_f32 v113, v113, v104
  v_add_f32 v113, v113, v105
  v_add_f32 v113, v113, v106
  v_add_f32 v113, v113, v107
  v_cvt_pk_bf16_f32 v108, v100, v101
  v_cvt_pk_bf16_f32 v109, v102, v103
  v_cvt_pk_bf16_f32 v110, v104, v105
  v_cvt_pk_bf16_f32 v111, v106, v107
  s_waitcnt lgkmcnt(0)
  s_nop 2
  v_mfma_f32_16x16x32_bf16 v[128:131], v[68:71], v[108:111], v[128:131]
  v_mfma_f32_16x16x32_bf16 v[132:135], v[72:75], v[108:111], v[132:135]
  v_mfma_f32_16x16x32_bf16 v[136:139], v[76:79], v[108:111], v[136:139]
  v_mfma_f32_16x16x32_bf16 v[140:143], v[80:83], v[108:111], v[140:143]
  v_mfma_f32_16x16x32_bf16 v[144:147], v[84:87], v[108:111], v[144:147]
  v_mfma_f32_16x16x32_bf16 v[148:151], v[88:91], v[108:111], v[148:151]
  v_mfma_f32_16x16x32_bf16 v[152:155], v[92:95], v[108:111], v[152:155]
  v_mfma_f32_16x16x32_bf16 v[156:159], v[96:99], v[108:111], v[156:159]
  s_nop 15
  s_add_u32 s49, s49, 8192
  s_cmp_lt_u32 s49, s53
  s_cbranch_scc1 L_fb_t
  v_mov_b32 v116, v113
  s_nop 2
  v_permlane16_swap_b32 v113, v116
  s_nop 2
  v_add_f32 v113, v113, v116
  v_mov_b32 v116, v113
  s_nop 2
  v_permlane32_swap_b32 v113, v116
  s_nop 2
  v_add_f32 v113, v113, v116
  v_rcp_f32 v113, v113
  s_nop 1
  v_mul_f32 v128, v128, v113
  v_mul_f32 v129, v129, v113
  v_mul_f32 v130, v130, v113
  v_mul_f32 v131, v131, v113
  v_mul_f32 v132, v132, v113
  v_mul_f32 v133, v133, v113
  v_mul_f32 v134, v134, v113
  v_mul_f32 v135, v135, v113
  v_mul_f32 v136, v136, v113
  v_mul_f32 v137, v137, v113
  v_mul_f32 v138, v138, v113
  v_mul_f32 v139, v139, v113
  v_mul_f32 v140, v140, v113
  v_mul_f32 v141, v141, v113
  v_mul_f32 v142, v142, v113
  v_mul_f32 v143, v143, v113
  v_mul_f32 v144, v144, v113
  v_mul_f32 v145, v145, v113
  v_mul_f32 v146, v146, v113
  v_mul_f32 v147, v147, v113
  v_mul_f32 v148, v148, v113
  v_mul_f32 v149, v149, v113
  v_mul_f32 v150, v150, v113
  v_mul_f32 v151, v151, v113
  v_mul_f32 v152, v152, v113
  v_mul_f32 v153, v153, v113
  v_mul_f32 v154, v154, v113
  v_mul_f32 v155, v155, v113
  v_mul_f32 v156, v156, v113
  v_mul_f32 v157, v157, v113
  v_mul_f32 v158, v158, v113
  v_mul_f32 v159, v159, v113
  v_cvt_pk_bf16_f32 v128, v128, v129
  v_cvt_pk_bf16_f32 v129, v130, v131
  buffer_store_dwordx2 v[128:129], v122, s[28:31], s50 offen offset:0
  v_cvt_pk_bf16_f32 v132, v132, v133
  v_cvt_pk_bf16_f32 v133, v134, v135
  buffer_store_dwordx2 v[132:133], v122, s[28:31], s50 offen offset:32
  v_cvt_pk_bf16_f32 v136, v136, v137
  v_cvt_pk_bf16_f32 v137, v138, v139
  buffer_store_dwordx2 v[136:137], v122, s[28:31], s50 offen offset:64
  v_cvt_pk_bf16_f32 v140, v140, v141
  v_cvt_pk_bf16_f32 v141, v142, v143
  buffer_store_dwordx2 v[140:141], v122, s[28:31], s50 offen offset:96
  v_cvt_pk_bf16_f32 v144, v144, v145
  v_cvt_pk_bf16_f32 v145, v146, v147
  buffer_store_dwordx2 v[144:145], v122, s[28:31], s50 offen offset:128
  v_cvt_pk_bf16_f32 v148, v148, v149
  v_cvt_pk_bf16_f32 v149, v150, v151
  buffer_store_dwordx2 v[148:149], v122, s[28:31], s50 offen offset:160
  v_cvt_pk_bf16_f32 v152, v152, v153
  v_cvt_pk_bf16_f32 v153, v154, v155
  buffer_store_dwordx2 v[152:153], v122, s[28:31], s50 offen offset:192
  v_cvt_pk_bf16_f32 v156, v156, v157
  v_cvt_pk_bf16_f32 v157, v158, v159
  buffer_store_dwordx2 v[156:157], v122, s[28:31], s50 offen offset:224
  s_waitcnt vmcnt(0)
  s_add_u32 s48, s48, 1
  s_cmp_lt_u32 s48, 6
  s_cbranch_scc1 L_fb_q
  s_branch L_done
L_codeend:
.section .rodata,"a"
.p2align 6
.amdhsa_kernel standalone__mha_softmax__near_ridge_kernel
  .amdhsa_next_free_vgpr 512
  .amdhsa_next_free_sgpr 102
  .amdhsa_accum_offset 256
  .amdhsa_group_segment_fixed_size 0
  .amdhsa_kernarg_size 48
  .amdhsa_user_sgpr_count 2
  .amdhsa_user_sgpr_kernarg_segment_ptr 1
  .amdhsa_system_sgpr_workgroup_id_x 1
.end_amdhsa_kernel
```
